```python
import torch

def _softmax(x, axis=-1):
    return torch.softmax(x, dim=axis)
def _gelu(x):
    return torch.nn.functional.gelu(x, approximate="tanh")
def _silu(x):
    return torch.nn.functional.silu(x)
def _sigmoid(x):
    return torch.sigmoid(x)
def _layernorm(x, axis=-1, eps=1e-5):
    m = x.mean(dim=axis, keepdim=True)
    v = x.var(dim=axis, keepdim=True, unbiased=False)
    return (x - m) / torch.sqrt(v + eps)
def _scatter_add(tgt, idx, src, axis=0):
    return tgt.clone().index_add_(axis, idx, src)
def _segment_sum(src, seg, n):
    out = torch.zeros((n,) + src.shape[1:], dtype=src.dtype)
    return out.index_add_(0, seg, src)
def _pad(x, pw):
    flat = tuple(v for pair in reversed(pw) for v in pair)
    return torch.nn.functional.pad(x, flat)

kernel_name = 'parallel_sum__ssm_conv_h3__dense_activation_relu__prompt'

def setup_inputs():

    _w = (lambda a: (lambda t: t.to(torch.bfloat16) if t.is_floating_point() else t)(torch.as_tensor(a)))
    def _A_setup():
        B, S, D = 1, 2048, 512
        ks = 4
        return {
            "q": _w((lambda *s: torch.randn(*s, dtype=torch.bfloat16) * 0.05)(B, S, D)),
            "k": _w((lambda *s: torch.randn(*s, dtype=torch.bfloat16) * 0.4)(B, S, D)),
            "v": _w((lambda *s: torch.randn(*s, dtype=torch.bfloat16) * 0.4)(B, S, D)),
            "shift_k": _w((lambda *s: torch.randn(*s, dtype=torch.bfloat16) * 0.4)(D, ks) * 0.5),
            "ssm_k": _w((lambda *s: torch.randn(*s, dtype=torch.bfloat16) * 1.6)(D, S) * (1.0 / S ** 0.5)),
            "ssm_D": _w((lambda *s: torch.randn(*s, dtype=torch.bfloat16) * 0.4)(D)),
        }
    _A_in = _A_setup()

    def _B_setup():
        B, S, D, Dff = 1, 2048, 512, 1376
        return {
            "x": _w((lambda *s: torch.randn(*s, dtype=torch.bfloat16) * 0.05)(B, S, D)),
            "w1": _w((lambda *s: torch.randn(*s, dtype=torch.bfloat16) * 0.05)(D, Dff)),
            "w2": _w((lambda *s: torch.randn(*s, dtype=torch.bfloat16) * 0.05)(Dff, D)),
        }
    _B_in = _B_setup()

    return {
        "A_q": _A_in["q"],
        "A_k": _A_in["k"],
        "A_v": _A_in["v"],
        "A_shift_k": _A_in["shift_k"],
        "A_ssm_k": _A_in["ssm_k"],
        "A_ssm_D": _A_in["ssm_D"],
        "B_x": _B_in["x"],
        "B_w1": _B_in["w1"],
        "B_w2": _B_in["w2"],
    }

def reference(A_q, A_k, A_v, A_shift_k, A_ssm_k, A_ssm_D, B_x, B_w1, B_w2):
    def _A_ref(q, k, v, shift_k, ssm_k, ssm_D):
        B, S, D = q.shape
        ks = shift_k.shape[-1]
        k_pad = _pad(k, ((0, 0), (ks - 1, 0), (0, 0)))
        k_shift = torch.zeros_like(k)
        for t in range(ks):
            k_shift = k_shift + k_pad[:, t:t + S, :] * shift_k[:, ks - 1 - t][None, None, :]
        kv = k_shift * v
        L = 2 * S
        kv_pad = _pad(kv, ((0, 0), (0, S), (0, 0)))
        kf_pad = _pad(ssm_k, ((0, 0), (0, S)))
        kv_f = (lambda x, axes=(-2,-1): torch.fft.rfft2(x.float(), dim=axes))(kv_pad[:, None, :, :], axes=(1, 2))
        kf_f = (lambda x, axes=(-2,-1): torch.fft.rfft2(x.float(), dim=axes))(kf_pad[:, None, :], axes=(1, 2))
        kf_f = (lambda x, *d: x.permute(*d))(kf_f, 1, 2, 0)
        y_f = kv_f * kf_f[None, :, :, :]
        y = (lambda x, s, axes=(-2,-1): torch.fft.irfft2(x, s=s, dim=axes).to(torch.bfloat16))(y_f, (1, L), axes=(1, 2))[:, 0, :S, :]
        y = y + kv * ssm_D[None, None, :]
        return q * y

    def _B_ref(x, w1, w2):
        h = torch.einsum("bsd,df->bsf", x, w1)
        zero = torch.zeros_like(h)
        h = torch.maximum(h, zero)
        return torch.einsum("bsf,fd->bsd", h, w2)

    x = A_q
    xn = _layernorm(x, axis=-1)
    return x + _A_ref(xn, A_k, A_v, A_shift_k, A_ssm_k, A_ssm_D) + _B_ref(xn, B_w1, B_w2)
```

```asm
; @launch grid=(256,1,1) block=(256,1,1) lds=163840
.amdgcn_target "amdgcn-amd-amdhsa--gfx950"
.text
.globl parallel_sum__ssm_conv_h3__dense_activation_relu__prompt_kernel
.p2align 8
.type parallel_sum__ssm_conv_h3__dense_activation_relu__prompt_kernel,@function
parallel_sum__ssm_conv_h3__dense_activation_relu__prompt_kernel:
  s_cmp_ge_u32 s2, 256
  s_cbranch_scc1 LEND
  s_load_dwordx16 s[64:79], s[0:1], 0
  s_load_dwordx8 s[80:87], s[0:1], 64
  v_lshrrev_b32 v2, 6, v0
  v_and_b32 v1, 63, v0
  s_and_b32 s44, s2, 7
  v_readfirstlane_b32 s46, v2
  s_lshr_b32 s45, s2, 3
  v_and_b32 v3, 7, v0
  v_lshrrev_b32 v4, 3, v0
  s_lshl_b32 s3, s45, 16
  s_lshl_b32 s4, s44, 7
  s_add_u32 s3, s3, s4
  s_sub_u32 s3, s3, 3072
  v_lshlrev_b32 v5, 11, v4
  v_lshl_add_u32 v5, v3, 4, v5
  v_add_u32 v5, s3, v5
  v_add_u32 v6, 1024, v5
  v_add_u32 v7, 2048, v5
  v_add_u32 v8, 3072, v5
  v_lshlrev_b32 v17, 4, v1
  s_cmp_eq_u32 s46, 0
  s_cselect_b32 s48, -1, 0
  s_mov_b32 s49, 0
  s_cselect_b32 s50, 1, 0
  s_mov_b32 s51, 0
  v_mov_b32 v9, 0
  s_waitcnt lgkmcnt(0)
  s_mov_b32 s40, s86
  s_mov_b32 s41, s87
  s_mov_b32 s42, 33554432
  s_mov_b32 s43, 0x20000
  s_mov_b32 s12, s66
  s_mov_b32 s13, s67
  s_mov_b32 s14, 2097152
  s_mov_b32 s15, 0x20000
  s_mov_b32 s16, s68
  s_mov_b32 s17, s69
  s_mov_b32 s18, 2097152
  s_mov_b32 s19, 0x20000
  s_mov_b32 s20, s70
  s_mov_b32 s21, s71
  s_mov_b32 s22, 4096
  s_mov_b32 s23, 0x20000
  buffer_load_dword v19, v9, s[40:43], 0 offen sc1
  s_lshl_b32 s52, s46, 10
  s_lshl_b32 s4, s44, 9
  v_add_u32 v16, s4, v17
  s_add_u32 m0, s52, 256
  s_nop 0
  buffer_load_dwordx4 v16, s[20:23], 0 offen  lds
  buffer_load_dwordx4 v[20:23], v5, s[12:15], 0 offen
  buffer_load_dwordx4 v[24:27], v6, s[12:15], 0 offen
  buffer_load_dwordx4 v[28:31], v7, s[12:15], 0 offen
  buffer_load_dwordx4 v[32:35], v8, s[12:15], 0 offen
  buffer_load_dwordx4 v[36:39], v8, s[12:15], 0 offen offset:1024
  buffer_load_dwordx4 v[40:43], v8, s[16:19], 0 offen
  buffer_load_dwordx4 v[44:47], v8, s[16:19], 0 offen offset:1024
  s_mov_b32 s8, s64
  s_mov_b32 s9, s65
  s_mov_b32 s10, 2097152
  s_mov_b32 s11, 0x20000
  s_mov_b32 s24, s72
  s_mov_b32 s25, s73
  s_mov_b32 s26, 2097152
  s_mov_b32 s27, 0x20000
  s_mov_b32 s28, s78
  s_mov_b32 s29, s79
  s_mov_b32 s30, 1409024
  s_mov_b32 s31, 0x20000
  s_mov_b32 s32, s80
  s_mov_b32 s33, s81
  s_mov_b32 s34, 1409024
  s_mov_b32 s35, 0x20000
  s_mov_b32 s36, s82
  s_mov_b32 s37, s83
  s_mov_b32 s38, 2097152
  s_mov_b32 s39, 0x20000
  s_lshl_b32 s3, s44, 5
  s_add_u32 s53, s3, s45
  s_lshl_b32 s3, s53, 2
  s_load_dword s54, s[74:75], s3
  s_lshl_b32 s4, s53, 13
  s_lshl_b32 s5, s46, 11
  s_add_u32 s4, s4, s5
  buffer_load_dwordx4 v[48:51], v17, s[8:11], s4 offen
  buffer_load_dwordx4 v[52:55], v17, s[8:11], s4 offen offset:1024
  s_mul_i32 s5, s2, 5504
  v_lshlrev_b32 v144, 7, v1
  s_cmp_eq_u32 s46, 3
  s_cselect_b32 s6, -1, 0
  s_cselect_b32 s7, 0x7ff, 0
  s_mov_b64 exec, s[6:7]
  buffer_load_dword v144, v144, s[28:31], s5 offen
  s_mov_b64 exec, -1
  v_lshrrev_b32 v14, 3, v1
  v_lshrrev_b32 v15, 4, v1
  v_and_b32 v16, 7, v1
  v_add_u32 v243, 0, v15
  v_xor_b32 v243, v243, v16
  v_lshlrev_b32 v243, 4, v243
  v_lshl_add_u32 v243, v14, 10, v243
  v_add_u32 v244, 0, v243
  v_add_u32 v243, 4, v15
  v_xor_b32 v243, v243, v16
  v_lshlrev_b32 v243, 4, v243
  v_lshl_add_u32 v243, v14, 10, v243
  v_add_u32 v245, 8192, v243
  v_add_u32 v243, 0, v15
  v_xor_b32 v243, v243, v16
  v_lshlrev_b32 v243, 4, v243
  v_lshl_add_u32 v243, v14, 10, v243
  v_add_u32 v246, 16384, v243
  v_add_u32 v243, 4, v15
  v_xor_b32 v243, v243, v16
  v_lshlrev_b32 v243, 4, v243
  v_lshl_add_u32 v243, v14, 10, v243
  v_add_u32 v247, 24576, v243
  s_mul_i32 s3, s46, 192
  s_mov_b32 s4, 0x5556
  s_mov_b32 s5, 2752-192
  s_add_u32 s6, s3, 0
  v_add_u32 v243, s6, v1
  v_mul_u32_u24 v251, s4, v243
  v_lshrrev_b32 v251, 18, v251
  v_lshlrev_b32 v243, 4, v243
  v_mad_u32_u24 v248, v251, s5, v243
  s_add_u32 s6, s3, 64
  v_add_u32 v243, s6, v1
  v_mul_u32_u24 v251, s4, v243
  v_lshrrev_b32 v251, 18, v251
  v_lshlrev_b32 v243, 4, v243
  v_mad_u32_u24 v249, v251, s5, v243
  s_add_u32 s6, s3, 128
  v_add_u32 v243, s6, v1
  v_mul_u32_u24 v251, s4, v243
  v_lshrrev_b32 v251, 18, v251
  v_lshlrev_b32 v243, 4, v243
  v_mad_u32_u24 v250, v251, s5, v243
  s_and_b32 s3, s45, 1
  s_lshl_b32 s4, s44, 3
  s_lshl_b32 s3, s3, 2
  s_add_u32 s3, s3, s4
  s_add_u32 s59, s3, s46
  s_lshl_b32 s55, s59, 15
  s_lshr_b32 s60, s45, 1
  s_mul_i32 s60, s60, 3
  s_min_u32 s63, s60, 40
  s_lshl_b32 s56, s63, 6
  s_lshl_b32 s57, s46, 12
  s_mul_i32 s58, s46, 3072
  s_add_u32 m0, s58, 86016
  s_nop 0
  buffer_load_dwordx4 v248, s[28:31], s56 offen  lds
  s_add_u32 m0, s58, 87040
  s_nop 0
  buffer_load_dwordx4 v249, s[28:31], s56 offen  lds
  s_add_u32 m0, s58, 88064
  s_nop 0
  buffer_load_dwordx4 v250, s[28:31], s56 offen  lds
  s_add_u32 m0, s57, 69632
  s_nop 0
  buffer_load_dwordx4 v244, s[8:11], s55 offen  lds
  s_add_u32 m0, s57, 70656
  s_nop 0
  buffer_load_dwordx4 v245, s[8:11], s55 offen  lds
  s_add_u32 m0, s57, 71680
  s_nop 0
  buffer_load_dwordx4 v246, s[8:11], s55 offen  lds
  s_add_u32 m0, s57, 72704
  s_nop 0
  buffer_load_dwordx4 v247, s[8:11], s55 offen  lds
  s_add_u32 s55, s55, 128
  s_add_u32 s56, s56, 176128
  v_and_b32 v10, 127, v0
  v_lshrrev_b32 v11, 7, v0
  v_lshlrev_b32 v12, 4, v10
  v_lshl_add_u32 v12, v11, 12, v12
  s_lshl_b32 s4, s53, 13
  v_cmp_eq_u32 vcc, 0, v10
  v_add_u32 v12, s4, v12
  v_subrev_u32 v13, 16, v12
  v_cndmask_b32 v13, v13, -1, vcc
  v_mov_b32 v240, v12
  v_mov_b32 v241, v13
  v_mov_b32 v88, 0
  v_mov_b32 v89, 0
  v_mov_b32 v90, 0
  v_mov_b32 v91, 0
  v_lshrrev_b32 v14, 4, v0
  s_movk_i32 s3, 4352
  v_and_b32 v15, 15, v0
  v_lshlrev_b32 v15, 4, v15
  v_mad_u32_u24 v14, v14, s3, v15
  ds_write_b128 v14, v[88:91] offset:0
  s_mov_b32 s3, 34816
  v_lshlrev_b32 v14, 4, v10
  v_mad_u32_u24 v251, v11, s3, v14
  v_lshl_add_u32 v12, v3, 6, s52
  s_lshl_b32 s3, s53, 2
  v_mov_b32 v18, s3
  s_mov_b32 s4, 0xffff0000
  s_mov_b32 s6, 0x01000504
  s_mov_b32 s7, 0x03020706
  v_sub_u32 v14, 31, v4
  v_lshlrev_b32 v15, 2, v3
  v_xor_b32 v14, v14, v15
  v_lshlrev_b32 v14, 2, v14
  v_lshl_add_u32 v14, v3, 10, v14
  v_add_u32 v14, 155648, v14
  v_lshrrev_b32 v15, 3, v4
  v_xor_b32 v13, v3, v15
  v_lshlrev_b32 v13, 4, v13
  v_lshl_add_u32 v13, v4, 7, v13
  v_add_u32 v13, 155648, v13
  v_xor_b32 v16, 64, v13
  v_lshlrev_b32 v10, 12, v4
  v_lshl_add_u32 v10, v3, 4, v10
  v_add_u32 v11, 0x20000, v10
  v_and_b32 v60, 15, v1
  v_lshrrev_b32 v60, 2, v60
  v_lshrrev_b32 v61, 5, v1
  v_lshl_add_u32 v60, v61, 3, v60
  v_mul_u32_u24 v60, 192, v60
  v_bfe_u32 v62, v1, 4, 1
  v_lshl_add_u32 v60, v62, 5, v60
  v_and_b32 v62, 3, v1
  v_lshl_add_u32 v60, v62, 3, v60
  v_add_u32 v60, 86016, v60
  v_and_b32 v63, 31, v1
  v_bfe_u32 v62, v1, 1, 3
  v_xor_b32 v62, v62, v61
  v_lshlrev_b32 v62, 4, v62
  v_lshl_add_u32 v62, v63, 7, v62
  v_add_u32 v62, s57, v62
  v_add_u32 v62, 69632, v62
  s_add_u32 s3, s46, 0
  s_and_b32 s3, s3, 3
  s_mul_i32 s5, s3, 3072
  s_lshl_b32 s3, s3, 5
  v_add_u32 v252, s5, v60
  v_xor_b32 v56, s3, v62
  s_add_u32 s3, s46, 1
  s_and_b32 s3, s3, 3
  s_mul_i32 s5, s3, 3072
  s_lshl_b32 s3, s3, 5
  v_add_u32 v253, s5, v60
  v_xor_b32 v57, s3, v62
  s_add_u32 s3, s46, 2
  s_and_b32 s3, s3, 3
  s_mul_i32 s5, s3, 3072
  s_lshl_b32 s3, s3, 5
  v_add_u32 v254, s5, v60
  v_xor_b32 v58, s3, v62
  s_add_u32 s3, s46, 3
  s_and_b32 s3, s3, 3
  s_mul_i32 s5, s3, 3072
  s_lshl_b32 s3, s3, 5
  v_add_u32 v255, s5, v60
  v_xor_b32 v59, s3, v62
  s_waitcnt vmcnt(17)
  v_add_u32 v19, 1, v19
  ds_read_b128 v[72:75], v12 offset:256
  ds_read_b128 v[76:79], v12 offset:272
  ds_read_b128 v[80:83], v12 offset:288
  ds_read_b128 v[84:87], v12 offset:304
  v_readfirstlane_b32 s47, v19
  s_waitcnt vmcnt(10)
  s_waitcnt lgkmcnt(0)
  v_perm_b32 v92, v24, v20, s6
  s_add_u32 m0, s58, 114688
  s_nop 0
  buffer_load_dwordx4 v248, s[28:31], s56 offen  lds
  v_perm_b32 v93, v28, v24, s6
  v_perm_b32 v94, v32, v28, s6
  v_perm_b32 v95, v36, v32, s6
  v_dot2_f32_bf16 v96, v92, v73, 0
  v_dot2_f32_bf16 v97, v93, v73, 0
  v_lshlrev_b32 v98, 16, v40
  v_lshlrev_b32 v99, 16, v44
  v_dot2_f32_bf16 v96, v94, v72, v96
  v_dot2_f32_bf16 v97, v95, v72, v97
  v_perm_b32 v108, v24, v20, s7
  v_perm_b32 v109, v28, v24, s7
  v_perm_b32 v110, v32, v28, s7
  v_perm_b32 v111, v36, v32, s7
  v_dot2_f32_bf16 v112, v108, v75, 0
  s_add_u32 m0, s58, 115712
  s_nop 0
  buffer_load_dwordx4 v249, s[28:31], s56 offen  lds
  v_dot2_f32_bf16 v113, v109, v75, 0
  v_and_b32 v114, s4, v40
  v_and_b32 v115, s4, v44
  v_dot2_f32_bf16 v112, v110, v74, v112
  v_dot2_f32_bf16 v113, v111, v74, v113
  v_mul_f32 v96, v96, v98
  v_mul_f32 v97, v97, v99
  v_cvt_pk_bf16_f32 v100, v97, v96
  ds_write_b32 v14, v100 offset:0
  v_perm_b32 v92, v25, v21, s6
  v_perm_b32 v93, v29, v25, s6
  v_perm_b32 v94, v33, v29, s6
  v_perm_b32 v95, v37, v33, s6
  v_dot2_f32_bf16 v96, v92, v77, 0
  s_add_u32 m0, s58, 116736
  s_nop 0
  buffer_load_dwordx4 v250, s[28:31], s56 offen  lds
  v_dot2_f32_bf16 v97, v93, v77, 0
  v_lshlrev_b32 v98, 16, v41
  v_lshlrev_b32 v99, 16, v45
  v_dot2_f32_bf16 v96, v94, v76, v96
  v_dot2_f32_bf16 v97, v95, v76, v97
  v_mul_f32 v112, v112, v114
  v_mul_f32 v113, v113, v115
  v_cvt_pk_bf16_f32 v116, v113, v112
  ds_write_b32 v14, v116 offset:128
  v_perm_b32 v108, v25, v21, s7
  v_perm_b32 v109, v29, v25, s7
  v_perm_b32 v110, v33, v29, s7
  v_perm_b32 v111, v37, v33, s7
  v_dot2_f32_bf16 v112, v108, v79, 0
  s_add_u32 m0, s57, 98304
  s_nop 0
  buffer_load_dwordx4 v244, s[8:11], s55 offen  lds
  v_dot2_f32_bf16 v113, v109, v79, 0
  v_and_b32 v114, s4, v41
  v_and_b32 v115, s4, v45
  v_dot2_f32_bf16 v112, v110, v78, v112
  v_dot2_f32_bf16 v113, v111, v78, v113
  v_mul_f32 v96, v96, v98
  v_mul_f32 v97, v97, v99
  v_cvt_pk_bf16_f32 v100, v97, v96
  ds_write_b32 v14, v100 offset:256
  v_perm_b32 v92, v26, v22, s6
  v_perm_b32 v93, v30, v26, s6
  v_perm_b32 v94, v34, v30, s6
  v_perm_b32 v95, v38, v34, s6
  v_dot2_f32_bf16 v96, v92, v81, 0
  s_add_u32 m0, s57, 99328
  s_nop 0
  buffer_load_dwordx4 v245, s[8:11], s55 offen  lds
  v_dot2_f32_bf16 v97, v93, v81, 0
  v_lshlrev_b32 v98, 16, v42
  v_lshlrev_b32 v99, 16, v46
  v_dot2_f32_bf16 v96, v94, v80, v96
  v_dot2_f32_bf16 v97, v95, v80, v97
  v_mul_f32 v112, v112, v114
  v_mul_f32 v113, v113, v115
  v_cvt_pk_bf16_f32 v116, v113, v112
  ds_write_b32 v14, v116 offset:384
  v_perm_b32 v108, v26, v22, s7
  v_perm_b32 v109, v30, v26, s7
  v_perm_b32 v110, v34, v30, s7
  v_perm_b32 v111, v38, v34, s7
  v_dot2_f32_bf16 v112, v108, v83, 0
  s_add_u32 m0, s57, 100352
  s_nop 0
  buffer_load_dwordx4 v246, s[8:11], s55 offen  lds
  v_dot2_f32_bf16 v113, v109, v83, 0
  v_and_b32 v114, s4, v42
  v_and_b32 v115, s4, v46
  v_dot2_f32_bf16 v112, v110, v82, v112
  v_dot2_f32_bf16 v113, v111, v82, v113
  v_mul_f32 v96, v96, v98
  v_mul_f32 v97, v97, v99
  v_cvt_pk_bf16_f32 v100, v97, v96
  ds_write_b32 v14, v100 offset:512
  v_perm_b32 v92, v27, v23, s6
  v_perm_b32 v93, v31, v27, s6
  v_perm_b32 v94, v35, v31, s6
  v_perm_b32 v95, v39, v35, s6
  v_dot2_f32_bf16 v96, v92, v85, 0
  s_add_u32 m0, s57, 101376
  s_nop 0
  buffer_load_dwordx4 v247, s[8:11], s55 offen  lds
  v_dot2_f32_bf16 v97, v93, v85, 0
  v_lshlrev_b32 v98, 16, v43
  v_lshlrev_b32 v99, 16, v47
  v_dot2_f32_bf16 v96, v94, v84, v96
  v_dot2_f32_bf16 v97, v95, v84, v97
  v_mul_f32 v112, v112, v114
  v_mul_f32 v113, v113, v115
  v_cvt_pk_bf16_f32 v116, v113, v112
  ds_write_b32 v14, v116 offset:640
  v_perm_b32 v108, v27, v23, s7
  v_perm_b32 v109, v31, v27, s7
  v_perm_b32 v110, v35, v31, s7
  v_perm_b32 v111, v39, v35, s7
  v_dot2_f32_bf16 v112, v108, v87, 0
  s_add_u32 s55, s55, 128
  s_add_u32 s56, s56, 176128
  v_dot2_f32_bf16 v113, v109, v87, 0
  v_and_b32 v114, s4, v43
  v_and_b32 v115, s4, v47
  v_dot2_f32_bf16 v112, v110, v86, v112
  v_dot2_f32_bf16 v113, v111, v86, v113
  v_mul_f32 v96, v96, v98
  v_mul_f32 v97, v97, v99
  v_cvt_pk_bf16_f32 v100, v97, v96
  ds_write_b32 v14, v100 offset:768
  s_nop 2
  v_mul_f32 v112, v112, v114
  v_mul_f32 v113, v113, v115
  v_cvt_pk_bf16_f32 v116, v113, v112
  ds_write_b32 v14, v116 offset:896
  s_lshl_b32 s5, s44, 18
  s_sub_u32 s6, 31, s45
  s_lshl_b32 s6, s6, 7
  s_add_u32 s5, s5, s6
  s_add_u32 s62, s5, 1048576
  s_waitcnt lgkmcnt(0)
  s_barrier
  ds_read_b128 v[40:43], v13
  ds_read_b128 v[44:47], v16 offset:4096
  s_add_u32 m0, s58, 143360
  s_nop 0
  buffer_load_dwordx4 v248, s[28:31], s56 offen  lds
  s_add_u32 m0, s58, 144384
  s_nop 0
  buffer_load_dwordx4 v249, s[28:31], s56 offen  lds
  s_add_u32 m0, s58, 145408
  s_nop 0
  buffer_load_dwordx4 v250, s[28:31], s56 offen  lds
  s_add_u32 m0, s57, 126976
  s_nop 0
  buffer_load_dwordx4 v244, s[8:11], s55 offen  lds
  s_waitcnt lgkmcnt(0)
  buffer_store_dwordx4 v[40:43], v10, s[40:43], s62 offen sc1
  buffer_store_dwordx4 v[44:47], v11, s[40:43], s62 offen sc1
  s_add_u32 m0, s57, 128000
  s_nop 0
  buffer_load_dwordx4 v245, s[8:11], s55 offen  lds
  s_add_u32 m0, s57, 129024
  s_nop 0
  buffer_load_dwordx4 v246, s[8:11], s55 offen  lds
  s_add_u32 m0, s57, 130048
  s_nop 0
  buffer_load_dwordx4 v247, s[8:11], s55 offen  lds
  s_add_u32 s55, s55, 128
  s_add_u32 s56, s56, 176128
  v_mov_b32 v3, v56
  v_mov_b32 v4, v57
  v_mov_b32 v5, v58
  v_mov_b32 v6, v59
  s_mul_i32 s5, s2, 5504
  v_lshlrev_b32 v60, 7, v1
  s_cmp_eq_u32 s46, 1
  s_cselect_b32 s6, -1, 0
  s_cselect_b32 s7, 0x7ff, 0
  s_mov_b64 exec, s[6:7]
  buffer_load_dword v60, v60, s[32:35], s5 offen
  s_mov_b64 exec, -1
  s_mov_b32 s61, 0x3f803f80
  v_accvgpr_write_b32 a224, s61
  v_accvgpr_write_b32 a225, s61
  v_accvgpr_write_b32 a226, s61
  v_accvgpr_write_b32 a227, s61
  s_lshl_b32 s3, s44, 7
  v_lshl_add_u32 v8, v1, 2, s3
  v_add_u32 v9, 12288, v8
  v_add_u32 v8, 8192, v8
  v_lshrrev_b32 v14, 3, v1
  v_and_b32 v15, 7, v1
  v_bfe_u32 v16, v1, 4, 1
  v_lshlrev_b32 v16, 2, v16
  v_xor_b32 v15, v15, v16
  v_lshlrev_b32 v15, 4, v15
  v_lshl_add_u32 v243, v14, 10, v15
  s_mul_i32 s64, s46, 360448
  s_lshr_b32 s65, s45, 2
  s_lshl_b32 s3, s65, 7
  s_add_u32 s64, s64, s3
  s_cmp_eq_u32 s46, 3
  s_cselect_b32 s66, 32768, 0
  s_waitcnt vmcnt(17)
  s_waitcnt lgkmcnt(0)
  s_barrier
  ds_read_b128 v[112:115], v3 offset:0
  v_lshlrev_b32 v20, 16, v48
  ds_read_b64_tr_b16 v[64:65], v252 offset:0
  v_and_b32 v21, s4, v48
  ds_read_b64_tr_b16 v[66:67], v252 offset:768
  v_lshlrev_b32 v22, 16, v49
  ds_read_b64_tr_b16 v[68:69], v252 offset:64
  v_and_b32 v23, s4, v49
  ds_read_b64_tr_b16 v[70:71], v252 offset:832
  v_lshlrev_b32 v24, 16, v50
  ds_read_b64_tr_b16 v[72:73], v252 offset:128
  v_and_b32 v25, s4, v50
  ds_read_b64_tr_b16 v[74:75], v252 offset:896
  v_lshlrev_b32 v26, 16, v51
  ds_read_b128 v[116:119], v4 offset:0
  v_and_b32 v27, s4, v51
  ds_read_b64_tr_b16 v[76:77], v253 offset:0
  v_lshlrev_b32 v28, 16, v52
  ds_read_b64_tr_b16 v[78:79], v253 offset:768
  v_and_b32 v29, s4, v52
  v_lshlrev_b32 v30, 16, v53
  ds_read_b64_tr_b16 v[80:81], v253 offset:64
  v_and_b32 v31, s4, v53
  ds_read_b64_tr_b16 v[82:83], v253 offset:832
  v_lshlrev_b32 v32, 16, v54
  ds_read_b64_tr_b16 v[84:85], v253 offset:128
  v_and_b32 v33, s4, v54
  ds_read_b64_tr_b16 v[86:87], v253 offset:896
  v_lshlrev_b32 v34, 16, v55
  ds_read_b128 v[120:123], v5 offset:0
  v_and_b32 v35, s4, v55
  ds_read_b64_tr_b16 v[88:89], v254 offset:0
  v_add_f32 v36, v20, v21
  ds_read_b64_tr_b16 v[90:91], v254 offset:768
  v_add_f32 v37, v28, v29
  ds_read_b64_tr_b16 v[92:93], v254 offset:64
  v_add_f32 v36, v36, v22
  ds_read_b64_tr_b16 v[94:95], v254 offset:832
  v_add_f32 v37, v37, v30
  v_add_f32 v36, v36, v23
  ds_read_b64_tr_b16 v[96:97], v254 offset:128
  v_add_f32 v37, v37, v31
  ds_read_b64_tr_b16 v[98:99], v254 offset:896
  v_add_f32 v36, v36, v24
  ds_read_b128 v[124:127], v6 offset:0
  v_add_f32 v37, v37, v32
  ds_read_b64_tr_b16 v[100:101], v255 offset:0
  v_add_f32 v36, v36, v25
  ds_read_b64_tr_b16 v[102:103], v255 offset:768
  v_add_f32 v37, v37, v33
  ds_read_b64_tr_b16 v[104:105], v255 offset:64
  v_add_f32 v36, v36, v26
  ds_read_b64_tr_b16 v[106:107], v255 offset:832
  v_add_f32 v37, v37, v34
  ds_read_b64_tr_b16 v[108:109], v255 offset:128
  v_add_f32 v36, v36, v27
  ds_read_b64_tr_b16 v[110:111], v255 offset:896
  v_add_f32 v37, v37, v35
  s_waitcnt vmcnt(10)
  s_waitcnt lgkmcnt(0)
  s_barrier
  v_mfma_f32_32x32x16_bf16 a[176:191], a[224:227], v[64:67], 0
  ds_read_b128 v[176:179], v3 offset:28672
  ds_read_b64_tr_b16 v[128:129], v252 offset:28672
  ds_read_b64_tr_b16 v[130:131], v252 offset:29440
  s_add_u32 m0, s58, 86016
  s_nop 0
  buffer_load_dwordx4 v248, s[28:31], s56 offen  lds
  s_nop 1
  v_permlane32_swap_b32 v36, v37
  s_nop 0
  v_add_f32 v36, v36, v37
  v_mov_b32 v37, v36
  s_nop 1
  v_permlane16_swap_b32 v36, v37
  v_mfma_f32_32x32x16_bf16 a[192:207], a[224:227], v[68:71], 0
  ds_read_b64_tr_b16 v[132:133], v252 offset:28736
  ds_read_b64_tr_b16 v[134:135], v252 offset:29504
  ds_read_b64_tr_b16 v[136:137], v252 offset:28800
  s_add_u32 m0, s58, 87040
  s_nop 0
  buffer_load_dwordx4 v249, s[28:31], s56 offen  lds
  s_nop 0
  v_add_f32 v36, v36, v37
  s_nop 1
  v_add_f32_dpp v36, v36, v36 row_mirror row_mask:0xf bank_mask:0xf
  s_nop 1
  v_add_f32_dpp v36, v36, v36 row_half_mirror row_mask:0xf bank_mask:0xf
  v_mfma_f32_32x32x16_bf16 a[208:223], a[224:227], v[72:75], 0
  ds_read_b64_tr_b16 v[138:139], v252 offset:29568
  ds_read_b128 v[180:183], v4 offset:28672
  s_nop 1
  v_add_f32_dpp v36, v36, v36 quad_perm:[1,0,3,2] row_mask:0xf bank_mask:0xf
  s_nop 1
  v_add_f32_dpp v36, v36, v36 quad_perm:[2,3,0,1] row_mask:0xf bank_mask:0xf
  v_mul_f32 v36, 0x3b000000, v36
  s_nop 0
  v_readlane_b32 s90, v36, 0
  v_readlane_b32 s91, v36, 32
  s_nop 1
  v_mfma_f32_32x32x16_bf16 v[192:207], v[64:67], v[112:115], 0
  ds_read_b64_tr_b16 v[140:141], v253 offset:28672
  ds_read_b64_tr_b16 v[142:143], v253 offset:29440
  ds_read_b64_tr_b16 v[144:145], v253 offset:28736
  s_add_u32 m0, s58, 88064
  s_nop 0
  buffer_load_dwordx4 v250, s[28:31], s56 offen  lds
  v_subrev_f32 v20, s90, v20
  v_subrev_f32 v21, s90, v21
  v_subrev_f32 v22, s90, v22
  v_mfma_f32_32x32x16_bf16 v[208:223], v[68:71], v[112:115], 0
  ds_read_b64_tr_b16 v[146:147], v253 offset:29504
  ds_read_b64_tr_b16 v[148:149], v253 offset:28800
  v_subrev_f32 v23, s90, v23
  v_subrev_f32 v24, s90, v24
  v_subrev_f32 v25, s90, v25
  v_mfma_f32_32x32x16_bf16 v[224:239], v[72:75], v[112:115], 0
  ds_read_b64_tr_b16 v[150:151], v253 offset:29568
  ds_read_b128 v[184:187], v5 offset:28672
  ds_read_b64_tr_b16 v[152:153], v254 offset:28672
  s_add_u32 m0, s57, 69632
  s_nop 0
  buffer_load_dwordx4 v244, s[8:11], s55 offen  lds
  v_subrev_f32 v26, s90, v26
  v_subrev_f32 v27, s90, v27
  v_subrev_f32 v28, s91, v28
  v_mfma_f32_32x32x16_bf16 v[192:207], v[76:79], v[116:119], v[192:207]
  ds_read_b64_tr_b16 v[154:155], v254 offset:29440
  ds_read_b64_tr_b16 v[156:157], v254 offset:28736
  v_subrev_f32 v29, s91, v29
  v_subrev_f32 v30, s91, v30
  v_subrev_f32 v31, s91, v31
  v_mfma_f32_32x32x16_bf16 v[208:223], v[80:83], v[116:119], v[208:223]
  ds_read_b64_tr_b16 v[158:159], v254 offset:29504
  ds_read_b64_tr_b16 v[160:161], v254 offset:28800
  ds_read_b64_tr_b16 v[162:163], v254 offset:29568
  s_add_u32 m0, s57, 70656
  s_nop 0
  buffer_load_dwordx4 v245, s[8:11], s55 offen  lds
  v_subrev_f32 v32, s91, v32
  v_subrev_f32 v33, s91, v33
  v_subrev_f32 v34, s91, v34
  v_mfma_f32_32x32x16_bf16 v[224:239], v[84:87], v[116:119], v[224:239]
  ds_read_b128 v[188:191], v6 offset:28672
  ds_read_b64_tr_b16 v[164:165], v255 offset:28672
  v_subrev_f32 v35, s91, v35
  v_mul_f32 v38, v20, v20
  v_mul_f32 v39, v28, v28
  v_mfma_f32_32x32x16_bf16 v[192:207], v[88:91], v[120:123], v[192:207]
  ds_read_b64_tr_b16 v[166:167], v255 offset:29440
  ds_read_b64_tr_b16 v[168:169], v255 offset:28736
  ds_read_b64_tr_b16 v[170:171], v255 offset:29504
  s_add_u32 m0, s57, 71680
  s_nop 0
  buffer_load_dwordx4 v246, s[8:11], s55 offen  lds
  v_fmac_f32 v38, v21, v21
  v_fmac_f32 v39, v29, v29
  v_fmac_f32 v38, v22, v22
  v_mfma_f32_32x32x16_bf16 v[208:223], v[92:95], v[120:123], v[208:223]
  ds_read_b64_tr_b16 v[172:173], v255 offset:28800
  ds_read_b64_tr_b16 v[174:175], v255 offset:29568
  v_fmac_f32 v39, v30, v30
  v_fmac_f32 v38, v23, v23
  v_fmac_f32 v39, v31, v31
  v_mfma_f32_32x32x16_bf16 v[224:239], v[96:99], v[120:123], v[224:239]
  s_add_u32 m0, s57, 72704
  s_nop 0
  buffer_load_dwordx4 v247, s[8:11], s55 offen  lds
  v_fmac_f32 v38, v24, v24
  v_fmac_f32 v39, v32, v32
  v_fmac_f32 v38, v25, v25
  v_mfma_f32_32x32x16_bf16 v[192:207], v[100:103], v[124:127], v[192:207]
  v_fmac_f32 v39, v33, v33
  v_fmac_f32 v38, v26, v26
  v_fmac_f32 v39, v34, v34
  v_mfma_f32_32x32x16_bf16 v[208:223], v[104:107], v[124:127], v[208:223]
  s_add_u32 s55, s55, 128
  s_add_u32 s56, s56, 176128
  v_fmac_f32 v38, v27, v27
  v_fmac_f32 v39, v35, v35
  v_mfma_f32_32x32x16_bf16 v[224:239], v[108:111], v[124:127], v[224:239]
  s_waitcnt vmcnt(8)
  s_waitcnt lgkmcnt(0)
  s_barrier
  v_mfma_f32_32x32x16_bf16 a[176:191], a[224:227], v[128:131], a[176:191]
  ds_read_b128 v[112:115], v3 offset:57344
  ds_read_b64_tr_b16 v[64:65], v252 offset:57344
  ds_read_b64_tr_b16 v[66:67], v252 offset:58112
  s_add_u32 m0, s58, 114688
  s_nop 0
  buffer_load_dwordx4 v248, s[28:31], s56 offen  lds
  s_nop 1
  v_permlane32_swap_b32 v38, v39
  s_nop 0
  v_add_f32 v38, v38, v39
  v_mov_b32 v39, v38
  v_mfma_f32_32x32x16_bf16 a[192:207], a[224:227], v[132:135], a[192:207]
  ds_read_b64_tr_b16 v[68:69], v252 offset:57408
  ds_read_b64_tr_b16 v[70:71], v252 offset:58176
  ds_read_b64_tr_b16 v[72:73], v252 offset:57472
  s_add_u32 m0, s58, 115712
  s_nop 0
  buffer_load_dwordx4 v249, s[28:31], s56 offen  lds
  s_nop 1
  v_permlane16_swap_b32 v38, v39
  v_mfma_f32_32x32x16_bf16 a[208:223], a[224:227], v[136:139], a[208:223]
  ds_read_b64_tr_b16 v[74:75], v252 offset:58240
  ds_read_b128 v[116:119], v4 offset:57344
  s_nop 0
  v_add_f32 v38, v38, v39
  s_nop 1
  v_add_f32_dpp v38, v38, v38 row_mirror row_mask:0xf bank_mask:0xf
  v_mfma_f32_32x32x16_bf16 v[192:207], v[128:131], v[176:179], v[192:207]
  ds_read_b64_tr_b16 v[76:77], v253 offset:57344
  ds_read_b64_tr_b16 v[78:79], v253 offset:58112
  ds_read_b64_tr_b16 v[80:81], v253 offset:57408
  s_add_u32 m0, s58, 116736
  s_nop 0
  buffer_load_dwordx4 v250, s[28:31], s56 offen  lds
  s_nop 1
  v_add_f32_dpp v38, v38, v38 row_half_mirror row_mask:0xf bank_mask:0xf
  v_mfma_f32_32x32x16_bf16 v[208:223], v[132:135], v[176:179], v[208:223]
  ds_read_b64_tr_b16 v[82:83], v253 offset:58176
  ds_read_b64_tr_b16 v[84:85], v253 offset:57472
  s_nop 1
  v_add_f32_dpp v38, v38, v38 quad_perm:[1,0,3,2] row_mask:0xf bank_mask:0xf
  s_nop 1
  v_add_f32_dpp v38, v38, v38 quad_perm:[2,3,0,1] row_mask:0xf bank_mask:0xf
  v_mfma_f32_32x32x16_bf16 v[224:239], v[136:139], v[176:179], v[224:239]
  ds_read_b64_tr_b16 v[86:87], v253 offset:58240
  ds_read_b128 v[120:123], v5 offset:57344
  ds_read_b64_tr_b16 v[88:89], v254 offset:57344
  s_add_u32 m0, s57, 98304
  s_nop 0
  buffer_load_dwordx4 v244, s[8:11], s55 offen  lds
  v_mul_f32 v38, 0x3b000000, v38
  v_mfma_f32_32x32x16_bf16 v[192:207], v[140:143], v[180:183], v[192:207]
  ds_read_b64_tr_b16 v[90:91], v254 offset:58112
  ds_read_b64_tr_b16 v[92:93], v254 offset:57408
  v_cvt_pk_bf16_f32 v36, v36, v36
  v_and_b32 v36, s4, v36
  v_mfma_f32_32x32x16_bf16 v[208:223], v[144:147], v[180:183], v[208:223]
  ds_read_b64_tr_b16 v[94:95], v254 offset:58176
  ds_read_b64_tr_b16 v[96:97], v254 offset:57472
  ds_read_b64_tr_b16 v[98:99], v254 offset:58240
  s_add_u32 m0, s57, 99328
  s_nop 0
  buffer_load_dwordx4 v245, s[8:11], s55 offen  lds
  v_cvt_pk_bf16_f32 v38, v38, v38
  v_mfma_f32_32x32x16_bf16 v[224:239], v[148:151], v[180:183], v[224:239]
  ds_read_b128 v[124:127], v6 offset:57344
  ds_read_b64_tr_b16 v[100:101], v255 offset:57344
  v_and_b32 v38, s4, v38
  v_add_f32 v38, 0x3727c5ac, v38
  v_mfma_f32_32x32x16_bf16 v[192:207], v[152:155], v[184:187], v[192:207]
  ds_read_b64_tr_b16 v[102:103], v255 offset:58112
  ds_read_b64_tr_b16 v[104:105], v255 offset:57408
  ds_read_b64_tr_b16 v[106:107], v255 offset:58176
  s_add_u32 m0, s57, 100352
  s_nop 0
  buffer_load_dwordx4 v246, s[8:11], s55 offen  lds
  v_cvt_pk_bf16_f32 v38, v38, v38
  v_mfma_f32_32x32x16_bf16 v[208:223], v[156:159], v[184:187], v[208:223]
  ds_read_b64_tr_b16 v[108:109], v255 offset:57472
  ds_read_b64_tr_b16 v[110:111], v255 offset:58240
  v_and_b32 v38, s4, v38
  v_sqrt_f32 v38, v38
  s_nop 0
  v_mfma_f32_32x32x16_bf16 v[224:239], v[160:163], v[184:187], v[224:239]
  s_add_u32 m0, s57, 101376
  s_nop 0
  buffer_load_dwordx4 v247, s[8:11], s55 offen  lds
  v_cvt_pk_bf16_f32 v38, v38, v38
  v_mfma_f32_32x32x16_bf16 v[192:207], v[164:167], v[188:191], v[192:207]
  v_and_b32 v38, s4, v38
  v_rcp_f32 v37, v38
  v_mfma_f32_32x32x16_bf16 v[208:223], v[168:171], v[188:191], v[208:223]
  s_add_u32 s55, s55, 128
  s_add_u32 s56, s56, 176128
  v_lshlrev_b32 v14, 3, v61
  s_lshl_b32 s5, s53, 6
  s_lshl_b32 s6, s46, 4
  s_add_u32 s5, s5, s6
  s_add_u32 s5, s5, 65536
  s_mov_b32 s6, 1
  s_mov_b32 s7, 1
  s_mov_b64 exec, s[6:7]
  buffer_store_dwordx2 v[36:37], v14, s[40:43], s5 offen sc1
  s_mov_b64 exec, -1
  v_mfma_f32_32x32x16_bf16 v[224:239], v[172:175], v[188:191], v[224:239]
  s_waitcnt vmcnt(8)
  s_waitcnt lgkmcnt(0)
  s_barrier
  v_mfma_f32_32x32x16_bf16 a[176:191], a[224:227], v[64:67], a[176:191]
  ds_read_b128 v[176:179], v3 offset:0
  ds_read_b64_tr_b16 v[128:129], v252 offset:0
  ds_read_b64_tr_b16 v[130:131], v252 offset:768
  s_add_u32 m0, s58, 143360
  s_nop 0
  buffer_load_dwordx4 v248, s[28:31], s56 offen  lds
  v_mfma_f32_32x32x16_bf16 a[192:207], a[224:227], v[68:71], a[192:207]
  ds_read_b64_tr_b16 v[132:133], v252 offset:64
  ds_read_b64_tr_b16 v[134:135], v252 offset:832
  ds_read_b64_tr_b16 v[136:137], v252 offset:128
  s_add_u32 m0, s58, 144384
  s_nop 0
  buffer_load_dwordx4 v249, s[28:31], s56 offen  lds
  v_mfma_f32_32x32x16_bf16 a[208:223], a[224:227], v[72:75], a[208:223]
  ds_read_b64_tr_b16 v[138:139], v252 offset:896
  ds_read_b128 v[180:183], v4 offset:0
  v_mfma_f32_32x32x16_bf16 v[192:207], v[64:67], v[112:115], v[192:207]
  ds_read_b64_tr_b16 v[140:141], v253 offset:0
  ds_read_b64_tr_b16 v[142:143], v253 offset:768
  ds_read_b64_tr_b16 v[144:145], v253 offset:64
  s_add_u32 m0, s58, 145408
  s_nop 0
  buffer_load_dwordx4 v250, s[28:31], s56 offen  lds
  v_mfma_f32_32x32x16_bf16 v[208:223], v[68:71], v[112:115], v[208:223]
  ds_read_b64_tr_b16 v[146:147], v253 offset:832
  ds_read_b64_tr_b16 v[148:149], v253 offset:128
  v_mfma_f32_32x32x16_bf16 v[224:239], v[72:75], v[112:115], v[224:239]
  ds_read_b64_tr_b16 v[150:151], v253 offset:896
  ds_read_b128 v[184:187], v5 offset:0
  ds_read_b64_tr_b16 v[152:153], v254 offset:0
  s_add_u32 m0, s57, 126976
  s_nop 0
  buffer_load_dwordx4 v244, s[8:11], s55 offen  lds
  v_mfma_f32_32x32x16_bf16 v[192:207], v[76:79], v[116:119], v[192:207]
  ds_read_b64_tr_b16 v[154:155], v254 offset:768
  ds_read_b64_tr_b16 v[156:157], v254 offset:64
  v_mfma_f32_32x32x16_bf16 v[208:223], v[80:83], v[116:119], v[208:223]
  ds_read_b64_tr_b16 v[158:159], v254 offset:832
  ds_read_b64_tr_b16 v[160:161], v254 offset:128
  ds_read_b64_tr_b16 v[162:163], v254 offset:896
  s_add_u32 m0, s57, 128000
  s_nop 0
  buffer_load_dwordx4 v245, s[8:11], s55 offen  lds
  v_mfma_f32_32x32x16_bf16 v[224:239], v[84:87], v[116:119], v[224:239]
  ds_read_b128 v[188:191], v6 offset:0
  ds_read_b64_tr_b16 v[164:165], v255 offset:0
  v_mfma_f32_32x32x16_bf16 v[192:207], v[88:91], v[120:123], v[192:207]
  ds_read_b64_tr_b16 v[166:167], v255 offset:768
  ds_read_b64_tr_b16 v[168:169], v255 offset:64
  ds_read_b64_tr_b16 v[170:171], v255 offset:832
  s_add_u32 m0, s57, 129024
  s_nop 0
  buffer_load_dwordx4 v246, s[8:11], s55 offen  lds
  v_mfma_f32_32x32x16_bf16 v[208:223], v[92:95], v[120:123], v[208:223]
  ds_read_b64_tr_b16 v[172:173], v255 offset:128
  ds_read_b64_tr_b16 v[174:175], v255 offset:896
  v_mfma_f32_32x32x16_bf16 v[224:239], v[96:99], v[120:123], v[224:239]
  s_add_u32 m0, s57, 130048
  s_nop 0
  buffer_load_dwordx4 v247, s[8:11], s55 offen  lds
  v_mfma_f32_32x32x16_bf16 v[192:207], v[100:103], v[124:127], v[192:207]
  v_mfma_f32_32x32x16_bf16 v[208:223], v[104:107], v[124:127], v[208:223]
  s_add_u32 s55, s55, 128
  s_add_u32 s56, s56, 176128
  v_mfma_f32_32x32x16_bf16 v[224:239], v[108:111], v[124:127], v[224:239]
  s_waitcnt vmcnt(8)
  s_waitcnt vmcnt(7)
  s_waitcnt lgkmcnt(0)
  s_barrier
  s_mov_b64 exec, s[50:51]
  s_mov_b32 s3, 8192
  buffer_store_dword v19, v18, s[40:43], s3 offen sc1
  s_mov_b64 exec, -1
  v_mfma_f32_32x32x16_bf16 a[176:191], a[224:227], v[128:131], a[176:191]
  ds_read_b128 v[112:115], v3 offset:28672
  ds_read_b64_tr_b16 v[64:65], v252 offset:28672
  ds_read_b64_tr_b16 v[66:67], v252 offset:29440
  s_add_u32 m0, s58, 86016
  s_nop 0
  buffer_load_dwordx4 v248, s[28:31], s56 offen  lds
  v_mfma_f32_32x32x16_bf16 a[192:207], a[224:227], v[132:135], a[192:207]
  ds_read_b64_tr_b16 v[68:69], v252 offset:28736
  ds_read_b64_tr_b16 v[70:71], v252 offset:29504
  ds_read_b64_tr_b16 v[72:73], v252 offset:28800
  s_add_u32 m0, s58, 87040
  s_nop 0
  buffer_load_dwordx4 v249, s[28:31], s56 offen  lds
  v_mfma_f32_32x32x16_bf16 a[208:223], a[224:227], v[136:139], a[208:223]
  ds_read_b64_tr_b16 v[74:75], v252 offset:29568
  ds_read_b128 v[116:119], v4 offset:28672
  v_mfma_f32_32x32x16_bf16 v[192:207], v[128:131], v[176:179], v[192:207]
  ds_read_b64_tr_b16 v[76:77], v253 offset:28672
  ds_read_b64_tr_b16 v[78:79], v253 offset:29440
  ds_read_b64_tr_b16 v[80:81], v253 offset:28736
  s_add_u32 m0, s58, 88064
  s_nop 0
  buffer_load_dwordx4 v250, s[28:31], s56 offen  lds
  v_mfma_f32_32x32x16_bf16 v[208:223], v[132:135], v[176:179], v[208:223]
  ds_read_b64_tr_b16 v[82:83], v253 offset:29504
  ds_read_b64_tr_b16 v[84:85], v253 offset:28800
  v_mfma_f32_32x32x16_bf16 v[224:239], v[136:139], v[176:179], v[224:239]
  ds_read_b64_tr_b16 v[86:87], v253 offset:29568
  ds_read_b128 v[120:123], v5 offset:28672
  ds_read_b64_tr_b16 v[88:89], v254 offset:28672
  s_add_u32 m0, s57, 69632
  s_nop 0
  buffer_load_dwordx4 v244, s[8:11], s55 offen  lds
  v_mfma_f32_32x32x16_bf16 v[192:207], v[140:143], v[180:183], v[192:207]
  ds_read_b64_tr_b16 v[90:91], v254 offset:29440
  ds_read_b64_tr_b16 v[92:93], v254 offset:28736
  v_mfma_f32_32x32x16_bf16 v[208:223], v[144:147], v[180:183], v[208:223]
  ds_read_b64_tr_b16 v[94:95], v254 offset:29504
  ds_read_b64_tr_b16 v[96:97], v254 offset:28800
  ds_read_b64_tr_b16 v[98:99], v254 offset:29568
  s_add_u32 m0, s57, 70656
  s_nop 0
  buffer_load_dwordx4 v245, s[8:11], s55 offen  lds
  v_mfma_f32_32x32x16_bf16 v[224:239], v[148:151], v[180:183], v[224:239]
  ds_read_b128 v[124:127], v6 offset:28672
  ds_read_b64_tr_b16 v[100:101], v255 offset:28672
  v_mfma_f32_32x32x16_bf16 v[192:207], v[152:155], v[184:187], v[192:207]
  ds_read_b64_tr_b16 v[102:103], v255 offset:29440
  ds_read_b64_tr_b16 v[104:105], v255 offset:28736
  ds_read_b64_tr_b16 v[106:107], v255 offset:29504
  s_add_u32 m0, s57, 71680
  s_nop 0
  buffer_load_dwordx4 v246, s[8:11], s55 offen  lds
  v_mfma_f32_32x32x16_bf16 v[208:223], v[156:159], v[184:187], v[208:223]
  ds_read_b64_tr_b16 v[108:109], v255 offset:28800
  ds_read_b64_tr_b16 v[110:111], v255 offset:29568
  v_mfma_f32_32x32x16_bf16 v[224:239], v[160:163], v[184:187], v[224:239]
  s_add_u32 m0, s57, 72704
  s_nop 0
  buffer_load_dwordx4 v247, s[8:11], s55 offen  lds
  v_mfma_f32_32x32x16_bf16 v[192:207], v[164:167], v[188:191], v[192:207]
  v_mfma_f32_32x32x16_bf16 v[208:223], v[168:171], v[188:191], v[208:223]
  s_add_u32 s55, s55, 128
  s_add_u32 s56, s56, 176128
  v_mfma_f32_32x32x16_bf16 v[224:239], v[172:175], v[188:191], v[224:239]
  s_waitcnt vmcnt(8)
  s_waitcnt lgkmcnt(0)
  s_barrier
  v_mfma_f32_32x32x16_bf16 a[176:191], a[224:227], v[64:67], a[176:191]
  ds_read_b128 v[176:179], v3 offset:57344
  ds_read_b64_tr_b16 v[128:129], v252 offset:57344
  ds_read_b64_tr_b16 v[130:131], v252 offset:58112
  s_add_u32 m0, s58, 114688
  s_nop 0
  buffer_load_dwordx4 v248, s[28:31], s56 offen  lds
  v_mfma_f32_32x32x16_bf16 a[192:207], a[224:227], v[68:71], a[192:207]
  ds_read_b64_tr_b16 v[132:133], v252 offset:57408
  ds_read_b64_tr_b16 v[134:135], v252 offset:58176
  ds_read_b64_tr_b16 v[136:137], v252 offset:57472
  s_add_u32 m0, s58, 115712
  s_nop 0
  buffer_load_dwordx4 v249, s[28:31], s56 offen  lds
  v_mfma_f32_32x32x16_bf16 a[208:223], a[224:227], v[72:75], a[208:223]
  ds_read_b64_tr_b16 v[138:139], v252 offset:58240
  ds_read_b128 v[180:183], v4 offset:57344
  v_mfma_f32_32x32x16_bf16 v[192:207], v[64:67], v[112:115], v[192:207]
  ds_read_b64_tr_b16 v[140:141], v253 offset:57344
  ds_read_b64_tr_b16 v[142:143], v253 offset:58112
  ds_read_b64_tr_b16 v[144:145], v253 offset:57408
  s_add_u32 m0, s58, 116736
  s_nop 0
  buffer_load_dwordx4 v250, s[28:31], s56 offen  lds
  v_mfma_f32_32x32x16_bf16 v[208:223], v[68:71], v[112:115], v[208:223]
  ds_read_b64_tr_b16 v[146:147], v253 offset:58176
  ds_read_b64_tr_b16 v[148:149], v253 offset:57472
  v_mfma_f32_32x32x16_bf16 v[224:239], v[72:75], v[112:115], v[224:239]
  ds_read_b64_tr_b16 v[150:151], v253 offset:58240
  ds_read_b128 v[184:187], v5 offset:57344
  ds_read_b64_tr_b16 v[152:153], v254 offset:57344
  s_add_u32 m0, s57, 98304
  s_nop 0
  buffer_load_dwordx4 v244, s[8:11], s55 offen  lds
  v_mfma_f32_32x32x16_bf16 v[192:207], v[76:79], v[116:119], v[192:207]
  ds_read_b64_tr_b16 v[154:155], v254 offset:58112
  ds_read_b64_tr_b16 v[156:157], v254 offset:57408
  v_mfma_f32_32x32x16_bf16 v[208:223], v[80:83], v[116:119], v[208:223]
  ds_read_b64_tr_b16 v[158:159], v254 offset:58176
  ds_read_b64_tr_b16 v[160:161], v254 offset:57472
  ds_read_b64_tr_b16 v[162:163], v254 offset:58240
  s_add_u32 m0, s57, 99328
  s_nop 0
  buffer_load_dwordx4 v245, s[8:11], s55 offen  lds
  v_mfma_f32_32x32x16_bf16 v[224:239], v[84:87], v[116:119], v[224:239]
  ds_read_b128 v[188:191], v6 offset:57344
  ds_read_b64_tr_b16 v[164:165], v255 offset:57344
  v_mfma_f32_32x32x16_bf16 v[192:207], v[88:91], v[120:123], v[192:207]
  ds_read_b64_tr_b16 v[166:167], v255 offset:58112
  ds_read_b64_tr_b16 v[168:169], v255 offset:57408
  ds_read_b64_tr_b16 v[170:171], v255 offset:58176
  s_add_u32 m0, s57, 100352
  s_nop 0
  buffer_load_dwordx4 v246, s[8:11], s55 offen  lds
  v_mfma_f32_32x32x16_bf16 v[208:223], v[92:95], v[120:123], v[208:223]
  ds_read_b64_tr_b16 v[172:173], v255 offset:57472
  ds_read_b64_tr_b16 v[174:175], v255 offset:58240
  v_mfma_f32_32x32x16_bf16 v[224:239], v[96:99], v[120:123], v[224:239]
  s_add_u32 m0, s57, 101376
  s_nop 0
  buffer_load_dwordx4 v247, s[8:11], s55 offen  lds
  v_mfma_f32_32x32x16_bf16 v[192:207], v[100:103], v[124:127], v[192:207]
  v_mfma_f32_32x32x16_bf16 v[208:223], v[104:107], v[124:127], v[208:223]
  s_add_u32 s55, s55, 128
  s_add_u32 s56, s56, 176128
  v_mfma_f32_32x32x16_bf16 v[224:239], v[108:111], v[124:127], v[224:239]
  s_waitcnt vmcnt(7)
  s_waitcnt lgkmcnt(0)
  s_barrier
  s_mov_b64 exec, s[48:49]
  buffer_load_dword v10, v8, s[40:43], 0 offen sc1
  s_mov_b64 exec, -1
  v_mfma_f32_32x32x16_bf16 a[176:191], a[224:227], v[128:131], a[176:191]
  ds_read_b128 v[112:115], v3 offset:0
  ds_read_b64_tr_b16 v[64:65], v252 offset:0
  ds_read_b64_tr_b16 v[66:67], v252 offset:768
  s_add_u32 m0, s57, 126976
  s_nop 0
  buffer_load_dwordx4 v243, s[32:35], s64 offen  lds
  s_add_u32 s64, s64, 8192
  v_mfma_f32_32x32x16_bf16 a[192:207], a[224:227], v[132:135], a[192:207]
  ds_read_b64_tr_b16 v[68:69], v252 offset:64
  ds_read_b64_tr_b16 v[70:71], v252 offset:832
  ds_read_b64_tr_b16 v[72:73], v252 offset:128
  v_mfma_f32_32x32x16_bf16 a[208:223], a[224:227], v[136:139], a[208:223]
  ds_read_b64_tr_b16 v[74:75], v252 offset:896
  ds_read_b128 v[116:119], v4 offset:0
  v_lshrrev_b32 v16, 5, v1
  v_bfe_u32 v14, v1, 2, 2
  v_mfma_f32_32x32x16_bf16 v[192:207], v[128:131], v[176:179], v[192:207]
  ds_read_b64_tr_b16 v[76:77], v253 offset:0
  ds_read_b64_tr_b16 v[78:79], v253 offset:768
  ds_read_b64_tr_b16 v[80:81], v253 offset:64
  s_add_u32 m0, s57, 128000
  s_nop 0
  buffer_load_dwordx4 v243, s[32:35], s64 offen  lds
  s_add_u32 s64, s64, 8192
  v_lshl_add_u32 v16, v16, 2, v14
  v_lshlrev_b32 v12, 7, v16
  v_mfma_f32_32x32x16_bf16 v[208:223], v[132:135], v[176:179], v[208:223]
  ds_read_b64_tr_b16 v[82:83], v253 offset:832
  ds_read_b64_tr_b16 v[84:85], v253 offset:128
  v_bfe_u32 v16, v16, 1, 1
  v_lshl_add_u32 v12, v16, 6, v12
  v_mfma_f32_32x32x16_bf16 v[224:239], v[136:139], v[176:179], v[224:239]
  ds_read_b64_tr_b16 v[86:87], v253 offset:896
  ds_read_b128 v[120:123], v5 offset:0
  ds_read_b64_tr_b16 v[88:89], v254 offset:0
  v_bfe_u32 v15, v1, 4, 1
  v_lshl_add_u32 v12, v15, 5, v12
  v_mfma_f32_32x32x16_bf16 v[192:207], v[140:143], v[180:183], v[192:207]
  ds_read_b64_tr_b16 v[90:91], v254 offset:768
  ds_read_b64_tr_b16 v[92:93], v254 offset:64
  s_add_u32 m0, s57, 129024
  s_nop 0
  buffer_load_dwordx4 v243, s[32:35], s64 offen  lds
  s_add_u32 s64, s64, 8192
  v_and_b32 v15, 3, v1
  v_lshl_add_u32 v12, v15, 3, v12
  v_mfma_f32_32x32x16_bf16 v[208:223], v[144:147], v[180:183], v[208:223]
  ds_read_b64_tr_b16 v[94:95], v254 offset:832
  ds_read_b64_tr_b16 v[96:97], v254 offset:128
  ds_read_b64_tr_b16 v[98:99], v254 offset:896
  s_add_u32 s6, s57, 69632
  v_add_u32 v12, s6, v12
  v_mfma_f32_32x32x16_bf16 v[224:239], v[148:151], v[180:183], v[224:239]
  ds_read_b128 v[124:127], v6 offset:0
  ds_read_b64_tr_b16 v[100:101], v255 offset:0
  v_xor_b32 v13, 64, v12
  v_lshrrev_b32 v14, 5, v1
  v_mfma_f32_32x32x16_bf16 v[192:207], v[152:155], v[184:187], v[192:207]
  ds_read_b64_tr_b16 v[102:103], v255 offset:768
  ds_read_b64_tr_b16 v[104:105], v255 offset:64
  ds_read_b64_tr_b16 v[106:107], v255 offset:832
  s_add_u32 m0, s57, 130048
  s_nop 0
  buffer_load_dwordx4 v243, s[32:35], s64 offen  lds
  s_add_u32 s64, s64, 8192
  v_mul_u32_u24 v14, 4608, v14
  v_and_b32 v15, 31, v1
  v_mfma_f32_32x32x16_bf16 v[208:223], v[156:159], v[184:187], v[208:223]
  ds_read_b64_tr_b16 v[108:109], v255 offset:128
  ds_read_b64_tr_b16 v[110:111], v255 offset:896
  v_lshl_add_u32 v14, v15, 4, v14
  v_add_u32 v14, 150528, v14
  v_mfma_f32_32x32x16_bf16 v[224:239], v[160:163], v[184:187], v[224:239]
  v_mov_b32 v36, 0
  v_mov_b32 v37, 0
  v_mfma_f32_32x32x16_bf16 v[192:207], v[164:167], v[188:191], v[192:207]
  buffer_load_dwordx4 v[20:23], v241, s[24:27], 0 offen offset:0
  buffer_load_dwordx4 v[24:27], v240, s[24:27], 0 offen offset:0
  buffer_load_dwordx4 v[28:31], v240, s[24:27], 0 offen offset:2032
  buffer_load_dwordx4 v[32:35], v240, s[24:27], 0 offen offset:2048
  ds_write_b64 v14, v[36:37]
  ds_write_b64 v14, v[36:37] offset:8
  v_mfma_f32_32x32x16_bf16 v[208:223], v[168:171], v[188:191], v[208:223]
  v_lshlrev_b32 v14, 3, v15
  v_mfma_f32_32x32x16_bf16 v[224:239], v[172:175], v[188:191], v[224:239]
  s_waitcnt vmcnt(9)
  s_waitcnt vmcnt(8)
  s_mov_b64 exec, s[48:49]
  s_mov_b32 s3, 0x8000
LB1:
  v_cmp_ne_u32 vcc, s47, v10
  s_nop 0
  s_cbranch_vccz LB2
  s_sub_u32 s3, s3, 1
  s_cbranch_scc1 LB2
  buffer_load_dword v10, v8, s[40:43], 0 offen sc1
  s_waitcnt vmcnt(0)
  s_branch LB1
LB2:
  s_mov_b64 exec, -1
  s_waitcnt lgkmcnt(0)
  s_barrier
  v_mfma_f32_32x32x16_bf16 a[176:191], a[224:227], v[64:67], a[176:191]
  ds_read_b128 v[176:179], v3 offset:28672
  ds_read_b64_tr_b16 v[128:129], v252 offset:28672
  ds_read_b64_tr_b16 v[130:131], v252 offset:29440
  s_lshl_b32 s3, s59, 8
  s_add_u32 s3, s3, 65536
  buffer_load_dword v11, v14, s[40:43], s3 offen sc1
  s_lshl_b32 s3, s53, 13
  s_lshl_b32 s4, s46, 11
  s_add_u32 s3, s3, s4
  s_add_u32 s3, s3, 1048576
  s_lshr_b32 s5, s46, 1
  s_lshl_b32 s5, s5, 9
  s_add_u32 s62, s5, s4
  v_mfma_f32_32x32x16_bf16 a[192:207], a[224:227], v[68:71], a[192:207]
  ds_read_b64_tr_b16 v[132:133], v252 offset:28736
  ds_read_b64_tr_b16 v[134:135], v252 offset:29504
  ds_read_b64_tr_b16 v[136:137], v252 offset:28800
  v_mfma_f32_32x32x16_bf16 a[208:223], a[224:227], v[72:75], a[208:223]
  ds_read_b64_tr_b16 v[138:139], v252 offset:29568
  ds_read_b128 v[180:183], v4 offset:28672
  s_add_u32 m0, s62, 146432
  s_nop 0
  buffer_load_dwordx4 v17, s[40:43], s3 offen sc1 lds
  v_lshrrev_b32 v16, 5, v1
  v_mfma_f32_32x32x16_bf16 v[192:207], v[64:67], v[112:115], v[192:207]
  ds_read_b64_tr_b16 v[140:141], v253 offset:28672
  ds_read_b64_tr_b16 v[142:143], v253 offset:29440
  ds_read_b64_tr_b16 v[144:145], v253 offset:28736
  s_lshl_b32 s6, s46, 3
  v_mfma_f32_32x32x16_bf16 v[208:223], v[68:71], v[112:115], v[208:223]
  ds_read_b64_tr_b16 v[146:147], v253 offset:29504
  ds_read_b64_tr_b16 v[148:149], v253 offset:28800
  s_add_u32 s3, s3, 1024
  s_add_u32 m0, s62, 147456
  s_nop 0
  buffer_load_dwordx4 v17, s[40:43], s3 offen sc1 lds
  v_mfma_f32_32x32x16_bf16 v[224:239], v[72:75], v[112:115], v[224:239]
  ds_read_b64_tr_b16 v[150:151], v253 offset:29568
  ds_read_b128 v[184:187], v5 offset:28672
  ds_read_b64_tr_b16 v[152:153], v254 offset:28672
  v_lshlrev_b32 v7, 5, v15
  v_mfma_f32_32x32x16_bf16 v[192:207], v[76:79], v[116:119], v[192:207]
  ds_read_b64_tr_b16 v[154:155], v254 offset:29440
  ds_read_b64_tr_b16 v[156:157], v254 offset:28736
  s_add_u32 m0, s57, 69632
  s_nop 0
  buffer_load_dwordx4 v243, s[32:35], s64 offen  lds
  s_add_u32 s64, s64, 8192
  v_lshl_add_u32 v2, v16, 2, v7
  v_mfma_f32_32x32x16_bf16 v[208:223], v[80:83], v[116:119], v[208:223]
  ds_read_b64_tr_b16 v[158:159], v254 offset:29504
  ds_read_b64_tr_b16 v[160:161], v254 offset:28800
  ds_read_b64_tr_b16 v[162:163], v254 offset:29568
  v_mfma_f32_32x32x16_bf16 v[224:239], v[84:87], v[116:119], v[224:239]
  ds_read_b128 v[188:191], v6 offset:28672
  ds_read_b64_tr_b16 v[164:165], v255 offset:28672
  s_add_u32 m0, s57, 70656
  s_nop 0
  buffer_load_dwordx4 v243, s[32:35], s64 offen  lds
  s_add_u32 s64, s64, 8192
  v_add_u32 v2, s6, v2
  v_mfma_f32_32x32x16_bf16 v[192:207], v[88:91], v[120:123], v[192:207]
  ds_read_b64_tr_b16 v[166:167], v255 offset:29440
  ds_read_b64_tr_b16 v[168:169], v255 offset:28736
  ds_read_b64_tr_b16 v[170:171], v255 offset:29504
  v_add_u32 v2, 155648, v2
  v_mfma_f32_32x32x16_bf16 v[208:223], v[92:95], v[120:123], v[208:223]
  ds_read_b64_tr_b16 v[172:173], v255 offset:28800
  ds_read_b64_tr_b16 v[174:175], v255 offset:29568
  s_add_u32 m0, s57, 71680
  s_nop 0
  buffer_load_dwordx4 v243, s[32:35], s64 offen  lds
  s_add_u32 s64, s64, 8192
  v_mfma_f32_32x32x16_bf16 v[224:239], v[96:99], v[120:123], v[224:239]
  v_lshl_add_u32 v7, v16, 4, v7
  v_mfma_f32_32x32x16_bf16 v[192:207], v[100:103], v[124:127], v[192:207]
  s_add_u32 m0, s57, 72704
  s_nop 0
  buffer_load_dwordx4 v243, s[32:35], s64 offen  lds
  s_add_u32 s64, s64, 8192
  v_add_u32 v7, 155648, v7
  v_mfma_f32_32x32x16_bf16 v[208:223], v[104:107], v[124:127], v[208:223]
  v_mfma_f32_32x32x16_bf16 v[224:239], v[108:111], v[124:127], v[224:239]
  s_waitcnt lgkmcnt(0)
  s_barrier
  v_mfma_f32_32x32x16_bf16 a[176:191], a[224:227], v[128:131], a[176:191]
  s_add_u32 m0, s57, 86016
  s_nop 0
  buffer_load_dwordx4 v243, s[32:35], s64 offen  lds
  s_add_u32 s64, s64, 8192
  v_mfma_f32_32x32x16_bf16 a[192:207], a[224:227], v[132:135], a[192:207]
  s_add_u32 m0, s57, 87040
  s_nop 0
  buffer_load_dwordx4 v243, s[32:35], s64 offen  lds
  s_add_u32 s64, s64, 8192
  v_mfma_f32_32x32x16_bf16 a[208:223], a[224:227], v[136:139], a[208:223]
  v_mfma_f32_32x32x16_bf16 v[192:207], v[128:131], v[176:179], v[192:207]
  s_add_u32 m0, s57, 88064
  s_nop 0
  buffer_load_dwordx4 v243, s[32:35], s64 offen  lds
  s_add_u32 s64, s64, 8192
  v_mfma_f32_32x32x16_bf16 v[208:223], v[132:135], v[176:179], v[208:223]
  v_mfma_f32_32x32x16_bf16 v[224:239], v[136:139], v[176:179], v[224:239]
  s_nop 7
  v_accvgpr_read_b32 v60, a176
  v_mul_f32 v60, 0.5, v60
  v_cvt_pk_bf16_f32 v36, v60, v60
  v_lshlrev_b32 v40, 16, v36
  s_add_u32 m0, s57, 89088
  s_nop 0
  buffer_load_dwordx4 v243, s[32:35], s64 offen  lds
  s_add_u32 s64, s64, 8192
  v_mfma_f32_32x32x16_bf16 v[192:207], v[140:143], v[180:183], v[192:207]
  v_sub_f32 v40, v60, v40
  v_cvt_pk_bf16_f32 v36, v60, v40
  ds_write_b32 v2, v36 offset:0
  v_accvgpr_read_b32 v61, a192
  v_mfma_f32_32x32x16_bf16 v[208:223], v[144:147], v[180:183], v[208:223]
  v_mul_f32 v61, 0.5, v61
  v_cvt_pk_bf16_f32 v37, v61, v61
  v_lshlrev_b32 v41, 16, v37
  v_sub_f32 v41, v61, v41
  v_cvt_pk_bf16_f32 v37, v61, v41
  s_add_u32 m0, s57, 102400
  s_nop 0
  buffer_load_dwordx4 v243, s[32:35], s64 offen  lds
  s_add_u32 s64, s64, 8192
  v_mfma_f32_32x32x16_bf16 v[224:239], v[148:151], v[180:183], v[224:239]
  ds_write_b32 v2, v37 offset:1024
  v_accvgpr_read_b32 v62, a208
  v_mul_f32 v62, 0.5, v62
  v_cvt_pk_bf16_f32 v38, v62, v62
  v_mfma_f32_32x32x16_bf16 v[192:207], v[152:155], v[184:187], v[192:207]
  v_lshlrev_b32 v42, 16, v38
  v_sub_f32 v42, v62, v42
  v_cvt_pk_bf16_f32 v38, v62, v42
  ds_write_b32 v2, v38 offset:2048
  s_add_u32 m0, s57, 103424
  s_nop 0
  buffer_load_dwordx4 v243, s[32:35], s64 offen  lds
  s_add_u32 s64, s64, 8192
  v_mfma_f32_32x32x16_bf16 v[208:223], v[156:159], v[184:187], v[208:223]
  s_waitcnt vmcnt(17)
  ds_read_b64_tr_b16 a[0:1], v12 offset:57344
  v_mfma_f32_32x32x16_bf16 v[224:239], v[160:163], v[184:187], v[224:239]
  s_add_u32 m0, s57, 104448
  s_nop 0
  buffer_load_dwordx4 v243, s[32:35], s64 offen  lds
  s_add_u32 s64, s64, 8192
  ds_read_b64_tr_b16 a[2:3], v12 offset:58368
  ds_read_b64_tr_b16 a[4:5], v13 offset:57344
  v_mfma_f32_32x32x16_bf16 v[192:207], v[164:167], v[188:191], v[192:207]
  ds_read_b64_tr_b16 a[6:7], v13 offset:58368
  ds_read_b64_tr_b16 a[8:9], v12 offset:59392
  v_mfma_f32_32x32x16_bf16 v[208:223], v[168:171], v[188:191], v[208:223]
  s_add_u32 m0, s57, 105472
  s_nop 0
  buffer_load_dwordx4 v243, s[32:35], s64 offen  lds
  s_add_u32 s64, s64, 8192
  ds_read_b64_tr_b16 a[10:11], v12 offset:60416
  ds_read_b64_tr_b16 a[12:13], v13 offset:59392
  v_mfma_f32_32x32x16_bf16 v[224:239], v[172:175], v[188:191], v[224:239]
  ds_read_b64_tr_b16 a[14:15], v13 offset:60416
  s_waitcnt lgkmcnt(0)
  s_barrier
  ds_read_b128 v[128:131], v7 offset:0
  ds_read_b128 v[132:135], v7 offset:1024
  ds_read_b128 v[136:139], v7 offset:2048
  s_add_u32 m0, s57, 126976
  s_nop 0
  buffer_load_dwordx4 v243, s[32:35], s64 offen  lds
  s_add_u32 s64, s64, 8192
  s_add_u32 m0, s57, 128000
  s_nop 0
  buffer_load_dwordx4 v243, s[32:35], s64 offen  lds
  s_add_u32 s64, s64, 8192
  s_add_u32 m0, s57, 129024
  s_nop 0
  buffer_load_dwordx4 v243, s[32:35], s64 offen  lds
  s_add_u32 s64, s64, 8192
  s_add_u32 m0, s57, 130048
  s_nop 0
  buffer_load_dwordx4 v243, s[32:35], s64 offen  lds
  s_add_u32 s64, s64, 8192
  s_waitcnt vmcnt(18)
  v_xor_b32 v11, 0x80000000, v11
  v_lshrrev_b32 v140, 16, v11
  v_or_b32 v140, v140, v11
  v_mov_b32 v141, v140
  v_mov_b32 v142, v140
  v_mov_b32 v143, v140
  s_mul_i32 s3, s59, 43
  s_add_u32 s3, s3, s63
  s_lshl_b32 s3, s3, 11
  s_add_u32 s67, s3, 6291456
  s_waitcnt lgkmcnt(0)
  v_mfma_f32_32x32x16_bf16 v[192:207], v[128:131], v[140:143], v[192:207]
  v_mfma_f32_32x32x16_bf16 v[208:223], v[132:135], v[140:143], v[208:223]
  v_mfma_f32_32x32x16_bf16 v[224:239], v[136:139], v[140:143], v[224:239]
  s_waitcnt vmcnt(12)
  ds_read_b64_tr_b16 a[16:17], v12 offset:0
  ds_read_b64_tr_b16 a[18:19], v12 offset:1024
  ds_read_b64_tr_b16 a[20:21], v13 offset:0
  ds_read_b64_tr_b16 a[22:23], v13 offset:1024
  ds_read_b64_tr_b16 a[24:25], v12 offset:2048
  ds_read_b64_tr_b16 a[26:27], v12 offset:3072
  ds_read_b64_tr_b16 a[28:29], v13 offset:2048
  ds_read_b64_tr_b16 a[30:31], v13 offset:3072
  v_and_b32 v14, 15, v1
  v_lshrrev_b32 v15, 4, v1
  v_add_u32 v16, 1, v14
  v_and_b32 v6, 7, v16
  v_lshrrev_b32 v16, 3, v16
  v_add_u32 v16, v16, v15
  s_mov_b32 s3, 0xc985410c
  v_lshlrev_b32 v7, 2, v6
  v_lshrrev_b32 v7, v7, s3
  v_and_b32 v7, 15, v7
  v_add_u32 v16, v16, v7
  v_mul_u32_u24 v6, 4352, v6
  v_lshl_add_u32 v4, v16, 4, v6
  s_lshr_b32 s4, s46, 1
  s_and_b32 s5, s46, 1
  s_mul_i32 s6, s4, 34816
  s_lshl_b32 s7, s5, 8
  s_add_u32 s6, s6, s7
  v_add_u32 v4, s6, v4
  s_mul_i32 s6, s4, 4608
  s_add_u32 s62, s6, 146432
  s_add_u32 s6, s62, s7
  s_add_u32 s6, s6, 480
  v_lshlrev_b32 v6, 5, v14
  v_lshlrev_b32 v7, 4, v15
  v_sub_u32 v5, v7, v6
  v_add_u32 v5, s6, v5
  s_lshl_b32 s7, s5, 11
  s_sub_u32 s6, s62, s7
  s_add_u32 s6, s6, 2552
  v_lshl_add_u32 v7, v15, 3, v6
  v_sub_u32 v6, s6, v7
  s_add_u32 s6, s57, 86016
  v_add_u32 v7, s6, v7
  s_lshl_b32 s6, s54, 16
  s_and_b32 s7, s54, 0xffff0000
  s_cmp_eq_u32 s4, 0
  s_cselect_b32 s54, s6, s7
  s_waitcnt lgkmcnt(0)
  s_add_u32 m0, s57, 69632
  s_nop 0
  buffer_load_dwordx4 v243, s[32:35], s64 offen  lds
  s_add_u32 s64, s64, 8192
  s_add_u32 m0, s57, 70656
  s_nop 0
  buffer_load_dwordx4 v243, s[32:35], s64 offen  lds
  s_add_u32 s64, s64, 8192
  s_add_u32 m0, s57, 71680
  s_nop 0
  buffer_load_dwordx4 v243, s[32:35], s64 offen  lds
  s_add_u32 s64, s64, 8192
  s_add_u32 m0, s57, 72704
  s_nop 0
  buffer_load_dwordx4 v243, s[32:35], s64 offen  lds
  s_add_u32 s64, s64, 8192
  v_cvt_pk_bf16_f32 v144, v192, v193
  v_cvt_pk_bf16_f32 v145, v194, v195
  v_cvt_pk_bf16_f32 v146, v196, v197
  v_cvt_pk_bf16_f32 v147, v198, v199
  v_cvt_pk_bf16_f32 v148, v200, v201
  v_cvt_pk_bf16_f32 v149, v202, v203
  v_cvt_pk_bf16_f32 v150, v204, v205
  v_cvt_pk_bf16_f32 v151, v206, v207
  v_pk_max_i16 v144, v144, 0
  v_pk_max_i16 v145, v145, 0
  v_pk_max_i16 v146, v146, 0
  v_pk_max_i16 v147, v147, 0
  v_pk_max_i16 v148, v148, 0
  v_pk_max_i16 v149, v149, 0
  v_pk_max_i16 v150, v150, 0
  v_pk_max_i16 v151, v151, 0
  s_add_u32 s4, s63, 0
  s_cmp_ge_u32 s4, s60
  s_cselect_b64 exec, -1, 0
  buffer_store_dwordx4 v[144:147], v17, s[40:43], s67 offen offset:0 sc1
  buffer_store_dwordx4 v[148:151], v17, s[40:43], s67 offen offset:1024 sc1
  s_mov_b64 exec, -1
  s_add_u32 s67, s67, 2048
  v_cvt_pk_bf16_f32 v152, v208, v209
  ds_write_b128 v251, v[20:23] offset:208
  v_cvt_pk_bf16_f32 v153, v210, v211
  v_mov_b32 v36, v21
  v_cvt_pk_bf16_f32 v154, v212, v213
  v_mov_b32 v37, v22
  v_cvt_pk_bf16_f32 v155, v214, v215
  v_mov_b32 v38, v23
  v_cvt_pk_bf16_f32 v156, v216, v217
  v_mov_b32 v39, v24
  v_cvt_pk_bf16_f32 v157, v218, v219
  v_mov_b32 v40, v25
  v_cvt_pk_bf16_f32 v158, v220, v221
  v_mov_b32 v41, v26
  v_cvt_pk_bf16_f32 v159, v222, v223
  ds_write_b128 v251, v[22:25] offset:17504
  v_pk_max_i16 v152, v152, 0
  v_alignbyte_b32 v42, v21, v20, 2
  v_pk_max_i16 v153, v153, 0
  v_alignbyte_b32 v43, v22, v21, 2
  v_pk_max_i16 v154, v154, 0
  v_alignbyte_b32 v44, v23, v22, 2
  v_pk_max_i16 v155, v155, 0
  v_alignbyte_b32 v45, v24, v23, 2
  v_pk_max_i16 v156, v156, 0
  v_alignbyte_b32 v46, v25, v24, 2
  v_pk_max_i16 v157, v157, 0
  v_alignbyte_b32 v47, v26, v25, 2
  v_pk_max_i16 v158, v158, 0
  ds_write_b128 v251, v[36:39] offset:8736
  v_pk_max_i16 v159, v159, 0
  ds_write_b128 v251, v[38:41] offset:26272
  s_add_u32 s4, s63, 1
  s_cmp_ge_u32 s4, s60
  s_cselect_b64 exec, -1, 0
  buffer_store_dwordx4 v[152:155], v17, s[40:43], s67 offen offset:0 sc1
  buffer_store_dwordx4 v[156:159], v17, s[40:43], s67 offen offset:1024 sc1
  s_mov_b64 exec, -1
  s_add_u32 s67, s67, 2048
  v_cvt_pk_bf16_f32 v160, v224, v225
  v_alignbyte_b32 v48, v22, v21, 2
  v_cvt_pk_bf16_f32 v161, v226, v227
  v_alignbyte_b32 v49, v23, v22, 2
  v_cvt_pk_bf16_f32 v162, v228, v229
  v_alignbyte_b32 v50, v24, v23, 2
  v_cvt_pk_bf16_f32 v163, v230, v231
  v_alignbyte_b32 v51, v25, v24, 2
  v_cvt_pk_bf16_f32 v164, v232, v233
  v_alignbyte_b32 v52, v26, v25, 2
  v_cvt_pk_bf16_f32 v165, v234, v235
  v_alignbyte_b32 v53, v27, v26, 2
  v_cvt_pk_bf16_f32 v166, v236, v237
  ds_write_b128 v251, v[42:45] offset:4368
  v_cvt_pk_bf16_f32 v167, v238, v239
  ds_write_b128 v251, v[44:47] offset:21904
  v_pk_max_i16 v160, v160, 0
  ds_write_b128 v251, v[48:51] offset:13136
  v_pk_max_i16 v161, v161, 0
  ds_write_b128 v251, v[50:53] offset:30672
  v_pk_max_i16 v162, v162, 0
  ds_write_b128 v251, v[28:31] offset:2256
  v_pk_max_i16 v163, v163, 0
  v_mov_b32 v36, v29
  v_pk_max_i16 v164, v164, 0
  v_mov_b32 v37, v30
  v_pk_max_i16 v165, v165, 0
  v_mov_b32 v38, v31
  v_pk_max_i16 v166, v166, 0
  v_mov_b32 v39, v32
  v_pk_max_i16 v167, v167, 0
  v_mov_b32 v40, v33
  s_add_u32 s4, s63, 2
  s_cmp_ge_u32 s4, s60
  s_cselect_b64 exec, -1, 0
  buffer_store_dwordx4 v[160:163], v17, s[40:43], s67 offen offset:0 sc1
  buffer_store_dwordx4 v[164:167], v17, s[40:43], s67 offen offset:1024 sc1
  s_mov_b64 exec, -1
  s_add_u32 s67, s67, 2048
  v_mov_b32 v41, v34
  ds_write_b128 v251, v[30:33] offset:19552
  ds_write_b128 v251, v[32:35] offset:2272
  v_alignbyte_b32 v42, v29, v28, 2
  v_alignbyte_b32 v43, v30, v29, 2
  v_alignbyte_b32 v44, v31, v30, 2
  v_alignbyte_b32 v45, v32, v31, 2
  v_alignbyte_b32 v46, v33, v32, 2
  v_alignbyte_b32 v47, v34, v33, 2
  ds_write_b128 v251, v[36:39] offset:10784
  ds_write_b128 v251, v[38:41] offset:28320
  v_alignbyte_b32 v48, v30, v29, 2
  v_alignbyte_b32 v49, v31, v30, 2
  v_alignbyte_b32 v50, v32, v31, 2
  v_alignbyte_b32 v51, v33, v32, 2
  v_alignbyte_b32 v52, v34, v33, 2
  v_alignbyte_b32 v53, v35, v34, 2
  ds_write_b128 v251, v[42:45] offset:6416
  ds_write_b128 v251, v[44:47] offset:23952
  ds_write_b128 v251, v[48:51] offset:15184
  ds_write_b128 v251, v[50:53] offset:32720
  s_waitcnt lgkmcnt(0)
  s_barrier
  ds_read_b128 v[64:67], v4 offset:0
  ds_read_b128 v[96:99], v5 offset:3584
  ds_read_b128 v[68:71], v4 offset:512
  ds_read_b128 v[100:103], v5 offset:3072
  ds_read_b128 v[72:75], v4 offset:1024
  ds_read_b128 v[104:107], v5 offset:2560
  ds_read_b128 v[76:79], v4 offset:1536
  ds_read_b128 v[108:111], v5 offset:2048
  ds_read_b128 v[80:83], v4 offset:2048
  ds_read_b128 v[112:115], v5 offset:1536
  ds_read_b128 v[84:87], v4 offset:2560
  ds_read_b128 v[116:119], v5 offset:1024
  ds_read_b128 v[88:91], v4 offset:3072
  ds_read_b128 v[120:123], v5 offset:512
  ds_read_b128 v[92:95], v4 offset:3584
  ds_read_b128 v[124:127], v5 offset:0
  s_lshr_b32 s3, s45, 1
  s_and_b32 s3, s3, 1
  s_lshl_b32 s68, 0x15555555, s3
  s_and_b32 s68, s68, s48
  s_mov_b32 s69, 0
  s_waitcnt lgkmcnt(14)
  v_mfma_f32_16x16x32_bf16 v[20:23], v[64:67], v[96:99], 0
  s_waitcnt lgkmcnt(12)
  v_mfma_f32_16x16x32_bf16 v[24:27], v[64:67], v[100:103], 0
  s_waitcnt vmcnt(18)
  ds_read_b64_tr_b16 a[32:33], v12 offset:16384
  v_mfma_f32_16x16x32_bf16 v[24:27], v[68:71], v[96:99], v[24:27]
  ds_read_b128 v[128:131], v4 offset:64
  ds_read_b64_tr_b16 a[34:35], v12 offset:17408
  v_mfma_f32_16x16x32_bf16 v[28:31], v[68:71], v[100:103], 0
  ds_read_b128 v[160:163], v5 offset:3648
  ds_read_b64_tr_b16 a[36:37], v13 offset:16384
  s_waitcnt lgkmcnt(15)
  v_mfma_f32_16x16x32_bf16 v[28:31], v[64:67], v[104:107], v[28:31]
  ds_read_b64_tr_b16 a[38:39], v13 offset:17408
  ds_read_b64_tr_b16 a[40:41], v12 offset:18432
  v_mfma_f32_16x16x32_bf16 v[32:35], v[68:71], v[104:107], 0
  ds_read_b128 v[132:135], v4 offset:576
  ds_read_b64_tr_b16 a[42:43], v12 offset:19456
  v_mfma_f32_16x16x32_bf16 v[28:31], v[72:75], v[96:99], v[28:31]
  ds_read_b64_tr_b16 a[44:45], v13 offset:18432
  v_mfma_f32_16x16x32_bf16 v[32:35], v[72:75], v[100:103], v[32:35]
  ds_read_b128 v[164:167], v5 offset:3136
  ds_read_b64_tr_b16 a[46:47], v13 offset:19456
  v_mfma_f32_16x16x32_bf16 v[36:39], v[72:75], v[104:107], 0
  s_waitcnt lgkmcnt(15)
  v_mfma_f32_16x16x32_bf16 v[32:35], v[64:67], v[108:111], v[32:35]
  ds_read_b128 v[136:139], v4 offset:1088
  s_waitcnt lgkmcnt(1)
  s_add_u32 m0, s57, 86016
  s_nop 0
  buffer_load_dwordx4 v243, s[32:35], s64 offen  lds
  s_add_u32 s64, s64, 8192
  v_mfma_f32_16x16x32_bf16 v[36:39], v[68:71], v[108:111], v[36:39]
  ds_read_b128 v[168:171], v5 offset:2624
  s_add_u32 m0, s57, 87040
  s_nop 0
  buffer_load_dwordx4 v243, s[32:35], s64 offen  lds
  s_add_u32 s64, s64, 8192
  v_mfma_f32_16x16x32_bf16 v[40:43], v[72:75], v[108:111], 0
  s_add_u32 m0, s57, 88064
  s_nop 0
  buffer_load_dwordx4 v243, s[32:35], s64 offen  lds
  s_add_u32 s64, s64, 8192
  s_add_u32 m0, s57, 89088
  s_nop 0
  buffer_load_dwordx4 v243, s[32:35], s64 offen  lds
  s_add_u32 s64, s64, 8192
  v_mfma_f32_16x16x32_bf16 v[32:35], v[76:79], v[96:99], v[32:35]
  ds_read_b128 v[140:143], v4 offset:1600
  s_waitcnt vmcnt(18)
  v_mfma_f32_16x16x32_bf16 v[36:39], v[76:79], v[100:103], v[36:39]
  ds_read_b64_tr_b16 a[48:49], v12 offset:32768
  v_mfma_f32_16x16x32_bf16 v[40:43], v[76:79], v[104:107], v[40:43]
  ds_read_b128 v[172:175], v5 offset:2112
  ds_read_b64_tr_b16 a[50:51], v12 offset:33792
  v_mfma_f32_16x16x32_bf16 v[44:47], v[76:79], v[108:111], 0
  ds_read_b64_tr_b16 a[52:53], v13 offset:32768
  ds_read_b64_tr_b16 a[54:55], v13 offset:33792
  v_mfma_f32_16x16x32_bf16 v[36:39], v[64:67], v[112:115], v[36:39]
  ds_read_b128 v[144:147], v4 offset:2112
  ds_read_b64_tr_b16 a[56:57], v12 offset:34816
  v_mfma_f32_16x16x32_bf16 v[40:43], v[68:71], v[112:115], v[40:43]
  ds_read_b128 v[176:179], v5 offset:1600
  ds_read_b64_tr_b16 a[58:59], v12 offset:35840
  v_mfma_f32_16x16x32_bf16 v[44:47], v[72:75], v[112:115], v[44:47]
  ds_read_b64_tr_b16 a[60:61], v13 offset:34816
  ds_read_b64_tr_b16 a[62:63], v13 offset:35840
  v_mfma_f32_16x16x32_bf16 v[48:51], v[76:79], v[112:115], 0
  ds_read_b128 v[148:151], v4 offset:2624
  v_mfma_f32_16x16x32_bf16 v[36:39], v[80:83], v[96:99], v[36:39]
  v_mfma_f32_16x16x32_bf16 v[40:43], v[80:83], v[100:103], v[40:43]
  ds_read_b128 v[180:183], v5 offset:1088
  s_waitcnt lgkmcnt(2)
  s_add_u32 m0, s57, 102400
  s_nop 0
  buffer_load_dwordx4 v243, s[32:35], s64 offen  lds
  s_add_u32 s64, s64, 8192
  v_mfma_f32_16x16x32_bf16 v[44:47], v[80:83], v[104:107], v[44:47]
  s_add_u32 m0, s57, 103424
  s_nop 0
  buffer_load_dwordx4 v243, s[32:35], s64 offen  lds
  s_add_u32 s64, s64, 8192
  s_add_u32 m0, s57, 104448
  s_nop 0
  buffer_load_dwordx4 v243, s[32:35], s64 offen  lds
  s_add_u32 s64, s64, 8192
  v_mfma_f32_16x16x32_bf16 v[48:51], v[80:83], v[108:111], v[48:51]
  ds_read_b128 v[152:155], v4 offset:3136
  s_add_u32 m0, s57, 105472
  s_nop 0
  buffer_load_dwordx4 v243, s[32:35], s64 offen  lds
  s_add_u32 s64, s64, 8192
  v_mfma_f32_16x16x32_bf16 v[40:43], v[64:67], v[116:119], v[40:43]
  ds_read_b128 v[184:187], v5 offset:576
  s_waitcnt vmcnt(18)
  v_mfma_f32_16x16x32_bf16 v[44:47], v[68:71], v[116:119], v[44:47]
  ds_read_b64_tr_b16 a[64:65], v12 offset:57344
  ds_read_b64_tr_b16 a[66:67], v12 offset:58368
  v_mfma_f32_16x16x32_bf16 v[48:51], v[72:75], v[116:119], v[48:51]
  ds_read_b128 v[156:159], v4 offset:3648
  ds_read_b64_tr_b16 a[68:69], v13 offset:57344
  v_mfma_f32_16x16x32_bf16 v[40:43], v[84:87], v[96:99], v[40:43]
  ds_read_b64_tr_b16 a[70:71], v13 offset:58368
  v_mfma_f32_16x16x32_bf16 v[44:47], v[84:87], v[100:103], v[44:47]
  ds_read_b128 v[188:191], v5 offset:64
  ds_read_b64_tr_b16 a[72:73], v12 offset:59392
  v_mfma_f32_16x16x32_bf16 v[48:51], v[84:87], v[104:107], v[48:51]
  ds_read_b64_tr_b16 a[74:75], v12 offset:60416
  ds_read_b64_tr_b16 a[76:77], v13 offset:59392
  v_mfma_f32_16x16x32_bf16 v[44:47], v[64:67], v[120:123], v[44:47]
  ds_read_b64_tr_b16 a[78:79], v13 offset:60416
  v_mfma_f32_16x16x32_bf16 v[48:51], v[68:71], v[120:123], v[48:51]
  v_mfma_f32_16x16x32_bf16 v[44:47], v[88:91], v[96:99], v[44:47]
  s_waitcnt lgkmcnt(0)
  s_add_u32 m0, s57, 126976
  s_nop 0
  buffer_load_dwordx4 v243, s[32:35], s64 offen  lds
  s_add_u32 s64, s64, 8192
  v_mfma_f32_16x16x32_bf16 v[48:51], v[88:91], v[100:103], v[48:51]
  s_add_u32 m0, s57, 128000
  s_nop 0
  buffer_load_dwordx4 v243, s[32:35], s64 offen  lds
  s_add_u32 s64, s64, 8192
  v_mfma_f32_16x16x32_bf16 v[48:51], v[64:67], v[124:127], v[48:51]
  s_add_u32 m0, s57, 129024
  s_nop 0
  buffer_load_dwordx4 v243, s[32:35], s64 offen  lds
  s_add_u32 s64, s64, 8192
  v_mfma_f32_16x16x32_bf16 v[48:51], v[92:95], v[96:99], v[48:51]
  s_add_u32 m0, s57, 130048
  s_nop 0
  buffer_load_dwordx4 v243, s[32:35], s64 offen  lds
  s_add_u32 s64, s64, 8192
  v_mfma_f32_16x16x32_bf16 v[20:23], v[128:131], v[160:163], v[20:23]
  v_mfma_f32_16x16x32_bf16 v[24:27], v[128:131], v[164:167], v[24:27]
  s_waitcnt vmcnt(18)
  v_mfma_f32_16x16x32_bf16 v[24:27], v[132:135], v[160:163], v[24:27]
  ds_read_b128 v[64:67], v4 offset:128
  v_mfma_f32_16x16x32_bf16 v[28:31], v[132:135], v[164:167], v[28:31]
  ds_read_b128 v[96:99], v5 offset:3712
  ds_read_b64_tr_b16 a[80:81], v12 offset:0
  v_mfma_f32_16x16x32_bf16 v[28:31], v[128:131], v[168:171], v[28:31]
  v_mfma_f32_16x16x32_bf16 v[32:35], v[132:135], v[168:171], v[32:35]
  ds_read_b128 v[68:71], v4 offset:640
  ds_read_b64_tr_b16 a[82:83], v12 offset:1024
  v_mfma_f32_16x16x32_bf16 v[28:31], v[136:139], v[160:163], v[28:31]
  v_mfma_f32_16x16x32_bf16 v[32:35], v[136:139], v[164:167], v[32:35]
  ds_read_b128 v[100:103], v5 offset:3200
  v_mfma_f32_16x16x32_bf16 v[36:39], v[136:139], v[168:171], v[36:39]
  ds_read_b64_tr_b16 a[84:85], v13 offset:0
  v_mfma_f32_16x16x32_bf16 v[32:35], v[128:131], v[172:175], v[32:35]
  ds_read_b128 v[72:75], v4 offset:1152
  v_mfma_f32_16x16x32_bf16 v[36:39], v[132:135], v[172:175], v[36:39]
  ds_read_b128 v[104:107], v5 offset:2688
  s_waitcnt vmcnt(12)
  s_barrier
  s_mov_b64 exec, s[50:51]
  s_mov_b32 s3, 12288
  buffer_store_dword v19, v18, s[40:43], s3 offen sc1
  s_mov_b64 exec, -1
  ds_read_b64_tr_b16 a[86:87], v13 offset:1024
  v_mfma_f32_16x16x32_bf16 v[40:43], v[136:139], v[172:175], v[40:43]
  v_mfma_f32_16x16x32_bf16 v[32:35], v[140:143], v[160:163], v[32:35]
  ds_read_b128 v[76:79], v4 offset:1664
  ds_read_b64_tr_b16 a[88:89], v12 offset:2048
  v_mfma_f32_16x16x32_bf16 v[36:39], v[140:143], v[164:167], v[36:39]
  v_mfma_f32_16x16x32_bf16 v[40:43], v[140:143], v[168:171], v[40:43]
  ds_read_b128 v[108:111], v5 offset:2176
  v_mfma_f32_16x16x32_bf16 v[44:47], v[140:143], v[172:175], v[44:47]
  ds_read_b64_tr_b16 a[90:91], v12 offset:3072
  v_mfma_f32_16x16x32_bf16 v[36:39], v[128:131], v[176:179], v[36:39]
  ds_read_b128 v[80:83], v4 offset:2176
  v_mfma_f32_16x16x32_bf16 v[40:43], v[132:135], v[176:179], v[40:43]
  ds_read_b128 v[112:115], v5 offset:1664
  ds_read_b64_tr_b16 a[92:93], v13 offset:2048
  v_mfma_f32_16x16x32_bf16 v[44:47], v[136:139], v[176:179], v[44:47]
  v_mfma_f32_16x16x32_bf16 v[48:51], v[140:143], v[176:179], v[48:51]
  ds_read_b128 v[84:87], v4 offset:2688
  ds_read_b64_tr_b16 a[94:95], v13 offset:3072
  v_mfma_f32_16x16x32_bf16 v[36:39], v[144:147], v[160:163], v[36:39]
  v_mfma_f32_16x16x32_bf16 v[40:43], v[144:147], v[164:167], v[40:43]
  ds_read_b128 v[116:119], v5 offset:1152
  v_mfma_f32_16x16x32_bf16 v[44:47], v[144:147], v[168:171], v[44:47]
  v_mfma_f32_16x16x32_bf16 v[48:51], v[144:147], v[172:175], v[48:51]
  ds_read_b128 v[88:91], v4 offset:3200
  v_mfma_f32_16x16x32_bf16 v[40:43], v[128:131], v[180:183], v[40:43]
  ds_read_b128 v[120:123], v5 offset:640
  v_mfma_f32_16x16x32_bf16 v[44:47], v[132:135], v[180:183], v[44:47]
  v_mfma_f32_16x16x32_bf16 v[48:51], v[136:139], v[180:183], v[48:51]
  ds_read_b128 v[92:95], v4 offset:3712
  s_waitcnt lgkmcnt(4)
  s_add_u32 m0, s57, 69632
  s_nop 0
  buffer_load_dwordx4 v243, s[32:35], s64 offen  lds
  s_add_u32 s64, s64, 8192
  v_mfma_f32_16x16x32_bf16 v[40:43], v[148:151], v[160:163], v[40:43]
  v_mfma_f32_16x16x32_bf16 v[44:47], v[148:151], v[164:167], v[44:47]
  ds_read_b128 v[124:127], v5 offset:128
  v_mfma_f32_16x16x32_bf16 v[48:51], v[148:151], v[168:171], v[48:51]
  s_add_u32 m0, s57, 70656
  s_nop 0
  buffer_load_dwordx4 v243, s[32:35], s64 offen  lds
  s_add_u32 s64, s64, 8192
  v_mfma_f32_16x16x32_bf16 v[44:47], v[128:131], v[184:187], v[44:47]
  v_mfma_f32_16x16x32_bf16 v[48:51], v[132:135], v[184:187], v[48:51]
  s_add_u32 m0, s57, 71680
  s_nop 0
  buffer_load_dwordx4 v243, s[32:35], s64 offen  lds
  s_add_u32 s64, s64, 8192
  v_mfma_f32_16x16x32_bf16 v[44:47], v[152:155], v[160:163], v[44:47]
  v_mfma_f32_16x16x32_bf16 v[48:51], v[152:155], v[164:167], v[48:51]
  s_add_u32 m0, s57, 72704
  s_nop 0
  buffer_load_dwordx4 v243, s[32:35], s64 offen  lds
  s_add_u32 s64, s64, 8192
  v_mfma_f32_16x16x32_bf16 v[48:51], v[128:131], v[188:191], v[48:51]
  v_mfma_f32_16x16x32_bf16 v[48:51], v[156:159], v[160:163], v[48:51]
  v_mfma_f32_16x16x32_bf16 v[20:23], v[64:67], v[96:99], v[20:23]
  v_mfma_f32_16x16x32_bf16 v[24:27], v[64:67], v[100:103], v[24:27]
  v_mfma_f32_16x16x32_bf16 v[24:27], v[68:71], v[96:99], v[24:27]
  ds_read_b128 v[128:131], v4 offset:192
  v_mfma_f32_16x16x32_bf16 v[28:31], v[68:71], v[100:103], v[28:31]
  ds_read_b128 v[160:163], v5 offset:3776
  v_mfma_f32_16x16x32_bf16 v[28:31], v[64:67], v[104:107], v[28:31]
  v_mfma_f32_16x16x32_bf16 v[32:35], v[68:71], v[104:107], v[32:35]
  ds_read_b128 v[132:135], v4 offset:704
  v_mfma_f32_16x16x32_bf16 v[28:31], v[72:75], v[96:99], v[28:31]
  s_waitcnt vmcnt(13)
  ds_read_b64_tr_b16 a[96:97], v12 offset:16384
  v_mfma_f32_16x16x32_bf16 v[32:35], v[72:75], v[100:103], v[32:35]
  ds_read_b128 v[164:167], v5 offset:3264
  ds_read_b64_tr_b16 a[98:99], v12 offset:17408
  v_mfma_f32_16x16x32_bf16 v[36:39], v[72:75], v[104:107], v[36:39]
  ds_read_b64_tr_b16 a[100:101], v13 offset:16384
  v_mfma_f32_16x16x32_bf16 v[32:35], v[64:67], v[108:111], v[32:35]
  ds_read_b128 v[136:139], v4 offset:1216
  ds_read_b64_tr_b16 a[102:103], v13 offset:17408
  v_mfma_f32_16x16x32_bf16 v[36:39], v[68:71], v[108:111], v[36:39]
  ds_read_b128 v[168:171], v5 offset:2752
  ds_read_b64_tr_b16 a[104:105], v12 offset:18432
  v_mfma_f32_16x16x32_bf16 v[40:43], v[72:75], v[108:111], v[40:43]
  ds_read_b64_tr_b16 a[106:107], v12 offset:19456
  v_mfma_f32_16x16x32_bf16 v[32:35], v[76:79], v[96:99], v[32:35]
  ds_read_b128 v[140:143], v4 offset:1728
  ds_read_b64_tr_b16 a[108:109], v13 offset:18432
  v_mfma_f32_16x16x32_bf16 v[36:39], v[76:79], v[100:103], v[36:39]
  ds_read_b64_tr_b16 a[110:111], v13 offset:19456
  v_mfma_f32_16x16x32_bf16 v[40:43], v[76:79], v[104:107], v[40:43]
  ds_read_b128 v[172:175], v5 offset:2240
  v_mfma_f32_16x16x32_bf16 v[44:47], v[76:79], v[108:111], v[44:47]
  v_mfma_f32_16x16x32_bf16 v[36:39], v[64:67], v[112:115], v[36:39]
  ds_read_b128 v[144:147], v4 offset:2240
  s_waitcnt lgkmcnt(2)
  s_sub_u32 s64, s64, s66
  s_add_u32 m0, s57, 86016
  s_nop 0
  buffer_load_dwordx4 v243, s[32:35], s64 offen  lds
  s_add_u32 s64, s64, 8192
  s_add_u32 m0, s57, 87040
  s_nop 0
  buffer_load_dwordx4 v243, s[32:35], s64 offen  lds
  s_add_u32 s64, s64, 8192
  v_mfma_f32_16x16x32_bf16 v[40:43], v[68:71], v[112:115], v[40:43]
  ds_read_b128 v[176:179], v5 offset:1728
  s_add_u32 m0, s57, 88064
  s_nop 0
  buffer_load_dwordx4 v243, s[32:35], s64 offen  lds
  s_add_u32 s64, s64, 8192
  v_mfma_f32_16x16x32_bf16 v[44:47], v[72:75], v[112:115], v[44:47]
  s_add_u32 m0, s57, 89088
  s_nop 0
  buffer_load_dwordx4 v243, s[32:35], s64 offen  lds
  s_add_u32 s64, s64, 8192
  v_mfma_f32_16x16x32_bf16 v[48:51], v[76:79], v[112:115], v[48:51]
  ds_read_b128 v[148:151], v4 offset:2752
  s_waitcnt vmcnt(13)
  v_mfma_f32_16x16x32_bf16 v[36:39], v[80:83], v[96:99], v[36:39]
  ds_read_b64_tr_b16 a[112:113], v12 offset:32768
  v_mfma_f32_16x16x32_bf16 v[40:43], v[80:83], v[100:103], v[40:43]
  ds_read_b128 v[180:183], v5 offset:1216
  ds_read_b64_tr_b16 a[114:115], v12 offset:33792
  v_mfma_f32_16x16x32_bf16 v[44:47], v[80:83], v[104:107], v[44:47]
  ds_read_b64_tr_b16 a[116:117], v13 offset:32768
  v_mfma_f32_16x16x32_bf16 v[48:51], v[80:83], v[108:111], v[48:51]
  ds_read_b128 v[152:155], v4 offset:3264
  ds_read_b64_tr_b16 a[118:119], v13 offset:33792
  v_mfma_f32_16x16x32_bf16 v[40:43], v[64:67], v[116:119], v[40:43]
  ds_read_b128 v[184:187], v5 offset:704
  ds_read_b64_tr_b16 a[120:121], v12 offset:34816
  v_mfma_f32_16x16x32_bf16 v[44:47], v[68:71], v[116:119], v[44:47]
  ds_read_b64_tr_b16 a[122:123], v12 offset:35840
  v_mfma_f32_16x16x32_bf16 v[48:51], v[72:75], v[116:119], v[48:51]
  ds_read_b128 v[156:159], v4 offset:3776
  ds_read_b64_tr_b16 a[124:125], v13 offset:34816
  ds_read_b64_tr_b16 a[126:127], v13 offset:35840
  v_mfma_f32_16x16x32_bf16 v[40:43], v[84:87], v[96:99], v[40:43]
  s_waitcnt vmcnt(9)
  v_mfma_f32_16x16x32_bf16 v[44:47], v[84:87], v[100:103], v[44:47]
  ds_read_b128 v[188:191], v5 offset:192
  ds_read_b64_tr_b16 a[128:129], v12 offset:57344
  v_mfma_f32_16x16x32_bf16 v[48:51], v[84:87], v[104:107], v[48:51]
  ds_read_b64_tr_b16 a[130:131], v12 offset:58368
  v_mfma_f32_16x16x32_bf16 v[44:47], v[64:67], v[120:123], v[44:47]
  ds_read_b64_tr_b16 a[132:133], v13 offset:57344
  v_mfma_f32_16x16x32_bf16 v[48:51], v[68:71], v[120:123], v[48:51]
  ds_read_b64_tr_b16 a[134:135], v13 offset:58368
  v_mfma_f32_16x16x32_bf16 v[44:47], v[88:91], v[96:99], v[44:47]
  ds_read_b64_tr_b16 a[136:137], v12 offset:59392
  v_mfma_f32_16x16x32_bf16 v[48:51], v[88:91], v[100:103], v[48:51]
  ds_read_b64_tr_b16 a[138:139], v12 offset:60416
  v_mfma_f32_16x16x32_bf16 v[48:51], v[64:67], v[124:127], v[48:51]
  ds_read_b64_tr_b16 a[140:141], v13 offset:59392
  v_mfma_f32_16x16x32_bf16 v[48:51], v[92:95], v[96:99], v[48:51]
  ds_read_b64_tr_b16 a[142:143], v13 offset:60416
  v_mfma_f32_16x16x32_bf16 v[20:23], v[128:131], v[160:163], v[20:23]
  v_mfma_f32_16x16x32_bf16 v[24:27], v[128:131], v[164:167], v[24:27]
  v_mfma_f32_16x16x32_bf16 v[24:27], v[132:135], v[160:163], v[24:27]
  v_mfma_f32_16x16x32_bf16 v[28:31], v[132:135], v[164:167], v[28:31]
  v_mfma_f32_16x16x32_bf16 v[28:31], v[128:131], v[168:171], v[28:31]
  v_mfma_f32_16x16x32_bf16 v[32:35], v[132:135], v[168:171], v[32:35]
  v_mfma_f32_16x16x32_bf16 v[28:31], v[136:139], v[160:163], v[28:31]
  v_mfma_f32_16x16x32_bf16 v[32:35], v[136:139], v[164:167], v[32:35]
  v_mfma_f32_16x16x32_bf16 v[36:39], v[136:139], v[168:171], v[36:39]
  s_waitcnt lgkmcnt(15)
  v_mfma_f32_16x16x32_bf16 v[32:35], v[128:131], v[172:175], v[32:35]
  v_mfma_f32_16x16x32_bf16 v[36:39], v[132:135], v[172:175], v[36:39]
  s_waitcnt vmcnt(4)
  v_mfma_f32_16x16x32_bf16 v[40:43], v[136:139], v[172:175], v[40:43]
  ds_read_b64_tr_b16 a[144:145], v12 offset:0
  v_mfma_f32_16x16x32_bf16 v[32:35], v[140:143], v[160:163], v[32:35]
  ds_read_b64_tr_b16 a[146:147], v12 offset:1024
  v_mfma_f32_16x16x32_bf16 v[36:39], v[140:143], v[164:167], v[36:39]
  v_mfma_f32_16x16x32_bf16 v[40:43], v[140:143], v[168:171], v[40:43]
  ds_read_b64_tr_b16 a[148:149], v13 offset:0
  v_mfma_f32_16x16x32_bf16 v[44:47], v[140:143], v[172:175], v[44:47]
  ds_read_b64_tr_b16 a[150:151], v13 offset:1024
  s_waitcnt lgkmcnt(15)
  v_mfma_f32_16x16x32_bf16 v[36:39], v[128:131], v[176:179], v[36:39]
  v_mfma_f32_16x16x32_bf16 v[40:43], v[132:135], v[176:179], v[40:43]
  ds_read_b64_tr_b16 a[152:153], v12 offset:2048
  v_mfma_f32_16x16x32_bf16 v[44:47], v[136:139], v[176:179], v[44:47]
  ds_read_b64_tr_b16 a[154:155], v12 offset:3072
  v_mfma_f32_16x16x32_bf16 v[48:51], v[140:143], v[176:179], v[48:51]
  v_mfma_f32_16x16x32_bf16 v[36:39], v[144:147], v[160:163], v[36:39]
  ds_read_b64_tr_b16 a[156:157], v13 offset:2048
  v_mfma_f32_16x16x32_bf16 v[40:43], v[144:147], v[164:167], v[40:43]
  ds_read_b64_tr_b16 a[158:159], v13 offset:3072
  v_mfma_f32_16x16x32_bf16 v[44:47], v[144:147], v[168:171], v[44:47]
  v_mfma_f32_16x16x32_bf16 v[48:51], v[144:147], v[172:175], v[48:51]
  s_waitcnt vmcnt(0)
  s_waitcnt lgkmcnt(15)
  v_mfma_f32_16x16x32_bf16 v[40:43], v[128:131], v[180:183], v[40:43]
  s_mov_b64 exec, s[68:69]
  buffer_load_dword v10, v9, s[40:43], 0 offen sc1
  s_mov_b64 exec, -1
  ds_read_b64_tr_b16 a[160:161], v12 offset:16384
  v_mfma_f32_16x16x32_bf16 v[44:47], v[132:135], v[180:183], v[44:47]
  ds_read_b64_tr_b16 a[162:163], v12 offset:17408
  v_mfma_f32_16x16x32_bf16 v[48:51], v[136:139], v[180:183], v[48:51]
  v_mfma_f32_16x16x32_bf16 v[40:43], v[148:151], v[160:163], v[40:43]
  ds_read_b64_tr_b16 a[164:165], v13 offset:16384
  v_mfma_f32_16x16x32_bf16 v[44:47], v[148:151], v[164:167], v[44:47]
  ds_read_b64_tr_b16 a[166:167], v13 offset:17408
  v_mfma_f32_16x16x32_bf16 v[48:51], v[148:151], v[168:171], v[48:51]
  s_waitcnt lgkmcnt(15)
  v_mfma_f32_16x16x32_bf16 v[44:47], v[128:131], v[184:187], v[44:47]
  ds_read_b64_tr_b16 a[168:169], v12 offset:18432
  v_mfma_f32_16x16x32_bf16 v[48:51], v[132:135], v[184:187], v[48:51]
  ds_read_b64_tr_b16 a[170:171], v12 offset:19456
  v_mfma_f32_16x16x32_bf16 v[44:47], v[152:155], v[160:163], v[44:47]
  v_mfma_f32_16x16x32_bf16 v[48:51], v[152:155], v[164:167], v[48:51]
  ds_read_b64_tr_b16 a[172:173], v13 offset:18432
  s_waitcnt lgkmcnt(15)
  v_mfma_f32_16x16x32_bf16 v[48:51], v[128:131], v[188:191], v[48:51]
  ds_read_b64_tr_b16 a[174:175], v13 offset:19456
  v_mfma_f32_16x16x32_bf16 v[48:51], v[156:159], v[160:163], v[48:51]
  ds_read_b64 v[52:53], v6 offset:1536
  ds_read_b64 v[54:55], v6 offset:1024
  ds_read_b64 v[56:57], v6 offset:512
  ds_read_b64 v[58:59], v6 offset:0
  v_mov_b32 v2, v12
  v_mov_b32 v3, v13
  s_add_u32 s3, s57, 69632
  v_add_u32 v12, s3, v17
  s_xor_b32 s4, s57, 4096
  s_add_u32 s4, s4, 69632
  v_add_u32 v13, s4, v17
  s_and_b32 s3, s45, 3
  s_lshl_b32 s4, s44, 2
  s_add_u32 s59, s3, s4
  s_mul_i32 s3, s59, 176128
  s_mul_i32 s4, s46, 22528
  s_add_u32 s3, s3, s4
  s_add_u32 s60, s3, 6291456
  s_add_u32 s61, s60, 88064
  s_lshr_b32 s66, s66, 4
  s_waitcnt lgkmcnt(0)
  s_and_b32 s3, s46, 1
  s_cbranch_scc1 LB3
  ds_write_b128 v12, v[36:39] offset:0
  ds_write_b128 v12, v[40:43] offset:1024
  ds_write_b128 v12, v[44:47] offset:2048
  ds_write_b128 v12, v[48:51] offset:3072
  s_branch LB4
LB3:
  ds_write_b128 v12, v[20:23] offset:0
  ds_write_b128 v12, v[24:27] offset:1024
  ds_write_b128 v12, v[28:31] offset:2048
  ds_write_b128 v12, v[32:35] offset:3072
  s_waitcnt lgkmcnt(0)
  v_mov_b32 v20, v36
  v_mov_b32 v21, v37
  v_mov_b32 v22, v38
  v_mov_b32 v23, v39
  v_mov_b32 v24, v40
  v_mov_b32 v25, v41
  v_mov_b32 v26, v42
  v_mov_b32 v27, v43
  v_mov_b32 v28, v44
  v_mov_b32 v29, v45
  v_mov_b32 v30, v46
  v_mov_b32 v31, v47
  v_mov_b32 v32, v48
  v_mov_b32 v33, v49
  v_mov_b32 v34, v50
  v_mov_b32 v35, v51
LB4:
  s_mov_b32 s4, 0xffff0000
  v_and_b32 v60, s4, v53
  v_lshlrev_b32 v61, 16, v53
  v_and_b32 v62, s4, v52
  v_lshlrev_b32 v63, 16, v52
  v_fmac_f32 v20, s54, v60
  v_fmac_f32 v21, s54, v61
  v_fmac_f32 v22, s54, v62
  v_fmac_f32 v23, s54, v63
  v_and_b32 v60, s4, v55
  v_lshlrev_b32 v61, 16, v55
  v_and_b32 v62, s4, v54
  v_lshlrev_b32 v63, 16, v54
  v_fmac_f32 v24, s54, v60
  v_fmac_f32 v25, s54, v61
  v_fmac_f32 v26, s54, v62
  v_fmac_f32 v27, s54, v63
  v_and_b32 v60, s4, v57
  v_lshlrev_b32 v61, 16, v57
  v_and_b32 v62, s4, v56
  v_lshlrev_b32 v63, 16, v56
  v_fmac_f32 v28, s54, v60
  v_fmac_f32 v29, s54, v61
  v_fmac_f32 v30, s54, v62
  v_fmac_f32 v31, s54, v63
  v_and_b32 v60, s4, v59
  v_lshlrev_b32 v61, 16, v59
  v_and_b32 v62, s4, v58
  v_lshlrev_b32 v63, 16, v58
  v_fmac_f32 v32, s54, v60
  v_fmac_f32 v33, s54, v61
  v_fmac_f32 v34, s54, v62
  v_fmac_f32 v35, s54, v63
  s_waitcnt vmcnt(0)
  s_mov_b64 exec, s[68:69]
  s_mov_b32 s3, 0x8000
LB5:
  v_cmp_ne_u32 vcc, s47, v10
  s_nop 0
  s_cbranch_vccz LB6
  s_sub_u32 s3, s3, 1
  s_cbranch_scc1 LB6
  buffer_load_dword v10, v9, s[40:43], 0 offen sc1
  s_waitcnt vmcnt(0)
  s_branch LB5
LB6:
  s_mov_b64 exec, -1
  s_waitcnt lgkmcnt(0)
  s_barrier
  ds_read_b128 v[36:39], v13 offset:0
  buffer_load_dwordx4 v[64:67], v17, s[40:43], s60 offen offset:0 sc1
  ds_read_b128 v[40:43], v13 offset:1024
  ds_read_b128 v[44:47], v13 offset:2048
  ds_read_b128 v[48:51], v13 offset:3072
  s_mov_b32 s4, 0xffff0000
  s_waitcnt lgkmcnt(3)
  v_add_f32 v20, v20, v36
  v_add_f32 v21, v21, v37
  v_add_f32 v22, v22, v38
  v_add_f32 v23, v23, v39
  v_cvt_pk_bf16_f32 v52, v20, v21
  v_cvt_pk_bf16_f32 v53, v22, v23
  buffer_load_dwordx4 v[68:71], v17, s[40:43], s61 offen offset:0 sc1
  ds_write_b64 v7, v[52:53] offset:0
  s_waitcnt lgkmcnt(3)
  v_add_f32 v24, v24, v40
  v_add_f32 v25, v25, v41
  v_add_f32 v26, v26, v42
  v_add_f32 v27, v27, v43
  v_cvt_pk_bf16_f32 v54, v24, v25
  v_cvt_pk_bf16_f32 v55, v26, v27
  ds_write_b64 v7, v[54:55] offset:512
  s_waitcnt lgkmcnt(3)
  v_add_f32 v28, v28, v44
  buffer_load_dwordx4 v[72:75], v17, s[40:43], s60 offen offset:1024 sc1
  s_add_u32 s60, s60, 2048
  v_add_f32 v29, v29, v45
  v_add_f32 v30, v30, v46
  v_add_f32 v31, v31, v47
  v_cvt_pk_bf16_f32 v56, v28, v29
  v_cvt_pk_bf16_f32 v57, v30, v31
  ds_write_b64 v7, v[56:57] offset:1024
  s_waitcnt lgkmcnt(3)
  v_add_f32 v32, v32, v48
  v_add_f32 v33, v33, v49
  v_add_f32 v34, v34, v50
  v_add_f32 v35, v35, v51
  buffer_load_dwordx4 v[76:79], v17, s[40:43], s61 offen offset:1024 sc1
  s_add_u32 s61, s61, 2048
  v_cvt_pk_bf16_f32 v58, v32, v33
  v_cvt_pk_bf16_f32 v59, v34, v35
  ds_write_b64 v7, v[58:59] offset:1536
  s_waitcnt lgkmcnt(0)
  ds_read_b128 v[20:23], v12 offset:16384
  ds_read_b128 v[24:27], v12 offset:17408
  s_lshl_b32 s3, s53, 13
  s_lshl_b32 s5, s46, 11
  s_add_u32 s3, s3, s5
  s_add_u32 s70, s3, 3145728
  s_waitcnt lgkmcnt(0)
  buffer_store_dwordx4 v[20:23], v17, s[40:43], s70 offen offset:0 sc1
  buffer_store_dwordx4 v[24:27], v17, s[40:43], s70 offen offset:1024 sc1
  s_cmp_lg_u32 s2, 255
  s_cbranch_scc1 LB7
  v_lshlrev_b32 v14, 2, v0
  v_add_u32 v14, 8192, v14
  v_mov_b32 v15, 0
  buffer_load_dword v15, v14, s[40:43], 0 offen sc1
  s_waitcnt vmcnt(0)
  s_mov_b64 exec, -1
  s_mov_b32 s3, 0x8000
LB8:
  v_cmp_ne_u32 vcc, s47, v15
  s_nop 0
  s_cbranch_vccz LB9
  s_sub_u32 s3, s3, 1
  s_cbranch_scc1 LB9
  buffer_load_dword v15, v14, s[40:43], 0 offen sc1
  s_waitcnt vmcnt(0)
  s_branch LB8
LB9:
  s_mov_b64 exec, -1
  s_barrier
  v_mov_b32 v14, 0
  s_mov_b64 exec, s[50:51]
  buffer_store_dword v19, v14, s[40:43], 0 offen sc1
  s_mov_b64 exec, -1
  s_waitcnt vmcnt(0)
LB7:
  buffer_load_dwordx4 v[80:83], v17, s[40:43], s60 offen offset:0 sc1
  buffer_load_dwordx4 v[84:87], v17, s[40:43], s61 offen offset:0 sc1
  buffer_load_dwordx4 v[88:91], v17, s[40:43], s60 offen offset:1024 sc1
  s_add_u32 s60, s60, 2048
  buffer_load_dwordx4 v[92:95], v17, s[40:43], s61 offen offset:1024 sc1
  s_add_u32 s61, s61, 2048
  s_waitcnt vmcnt(8)
  v_mfma_f32_32x32x16_bf16 a[176:191], a[0:3], v[64:67], 0
  buffer_load_dwordx4 v[96:99], v17, s[40:43], s60 offen offset:0 sc1
  v_lshrrev_b32 v4, 3, v0
  v_and_b32 v5, 7, v0
  v_lshlrev_b32 v14, 10, v4
  v_mfma_f32_32x32x16_bf16 a[192:207], a[4:7], v[64:67], 0
  buffer_load_dwordx4 v[100:103], v17, s[40:43], s61 offen offset:0 sc1
  v_lshl_add_u32 v14, v5, 4, v14
  v_add_u32 v15, 0x8000, v14
  v_mfma_f32_32x32x16_bf16 a[208:223], a[0:3], v[68:71], 0
  buffer_load_dwordx4 v[104:107], v17, s[40:43], s60 offen offset:1024 sc1
  s_add_u32 s60, s60, 2048
  v_lshlrev_b32 v16, 3, v4
  s_lshl_b32 s62, s59, 16
  s_lshl_b32 s3, s65, 7
  v_mfma_f32_32x32x16_bf16 a[224:239], a[4:7], v[68:71], 0
  s_add_u32 s62, s62, s3
  s_lshl_b32 s63, s59, 9
  s_waitcnt vmcnt(9)
  v_mfma_f32_32x32x16_bf16 a[176:191], a[8:11], v[72:75], a[176:191]
  buffer_load_dwordx4 v[108:111], v17, s[40:43], s61 offen offset:1024 sc1
  s_add_u32 s61, s61, 2048
  s_add_u32 s63, s63, 65536
  v_lshl_add_u32 v8, v1, 2, s3
  v_mfma_f32_32x32x16_bf16 a[192:207], a[12:15], v[72:75], a[192:207]
  buffer_load_dwordx4 v[112:115], v17, s[40:43], s60 offen offset:0 sc1
  v_add_u32 v8, 16384, v8
  v_and_b32 v12, 31, v1
  v_mul_u32_u24 v12, 272, v12
  v_mfma_f32_32x32x16_bf16 a[208:223], a[8:11], v[76:79], a[208:223]
  buffer_load_dwordx4 v[116:119], v17, s[40:43], s61 offen offset:0 sc1
  v_lshrrev_b32 v13, 5, v1
  v_lshl_add_u32 v12, v13, 4, v12
  v_mfma_f32_32x32x16_bf16 a[224:239], a[12:15], v[76:79], a[224:239]
  s_mul_i32 s3, s46, 17408
  v_add_u32 v12, s3, v12
  s_waitcnt vmcnt(10)
  s_barrier
  s_mov_b64 exec, s[50:51]
  s_mov_b32 s3, 16384
  buffer_store_dword v19, v18, s[40:43], s3 offen sc1
  s_mov_b64 exec, -1
  s_waitcnt vmcnt(9)
  v_mfma_f32_32x32x16_bf16 a[176:191], a[16:19], v[80:83], a[176:191]
  buffer_load_dwordx4 v[120:123], v17, s[40:43], s60 offen offset:1024 sc1
  s_add_u32 s60, s60, 2048
  v_lshrrev_b32 v13, 3, v4
  v_xor_b32 v13, v13, v5
  v_lshlrev_b32 v13, 4, v13
  v_lshl_add_u32 v13, v5, 10, v13
  v_mfma_f32_32x32x16_bf16 a[192:207], a[20:23], v[80:83], a[192:207]
  buffer_load_dwordx4 v[124:127], v17, s[40:43], s61 offen offset:1024 sc1
  s_add_u32 s61, s61, 2048
  v_and_b32 v6, 7, v4
  v_lshl_add_u32 v13, v6, 1, v13
  v_add_u32 v13, 155648, v13
  v_xor_b32 v7, 64, v13
  v_mfma_f32_32x32x16_bf16 a[208:223], a[16:19], v[84:87], a[208:223]
  buffer_load_dwordx4 v[128:131], v17, s[40:43], s60 offen offset:0 sc1
  v_mul_u32_u24 v6, 272, v4
  v_lshl_add_u32 v6, v5, 5, v6
  s_lshl_b32 s3, s65, 18
  s_lshl_b32 s4, s59, 7
  v_mfma_f32_32x32x16_bf16 a[224:239], a[20:23], v[84:87], a[224:239]
  s_add_u32 s3, s3, s4
  s_add_u32 s67, s3, 3145728
  s_lshl_b32 s70, s46, 11
  s_lshl_b32 s4, s46, 1
  s_waitcnt vmcnt(10)
  v_mfma_f32_32x32x16_bf16 a[176:191], a[24:27], v[88:91], a[176:191]
  buffer_load_dwordx4 v[132:135], v17, s[40:43], s61 offen offset:0 sc1
  s_add_u32 s4, s4, 0
  v_xor_b32 v2, s4, v5
  v_lshlrev_b32 v2, 4, v2
  v_lshrrev_b32 v9, 3, v1
  v_mfma_f32_32x32x16_bf16 a[192:207], a[28:31], v[88:91], a[192:207]
  buffer_load_dwordx4 v[136:139], v17, s[40:43], s60 offen offset:1024 sc1
  s_add_u32 s60, s60, 2048
  s_lshl_b32 s4, s4, 3
  v_add_u32 v9, s4, v9
  v_lshl_add_u32 v2, v9, 12, v2
  s_lshl_b32 s4, s46, 1
  v_mfma_f32_32x32x16_bf16 a[208:223], a[24:27], v[92:95], a[208:223]
  buffer_load_dwordx4 v[140:143], v17, s[40:43], s61 offen offset:1024 sc1
  s_add_u32 s61, s61, 2048
  s_add_u32 s4, s4, 1
  v_xor_b32 v3, s4, v5
  v_lshlrev_b32 v3, 4, v3
  v_lshrrev_b32 v9, 3, v1
  v_mfma_f32_32x32x16_bf16 a[224:239], a[28:31], v[92:95], a[224:239]
  s_lshl_b32 s4, s4, 3
  v_add_u32 v9, s4, v9
  v_lshl_add_u32 v3, v9, 12, v3
  s_waitcnt vmcnt(11)
  v_mfma_f32_32x32x16_bf16 a[176:191], a[32:35], v[96:99], a[176:191]
  buffer_load_dwordx4 v[144:147], v17, s[40:43], s60 offen offset:0 sc1
  v_mov_b32 v32, 0
  v_mov_b32 v33, 0
  v_mfma_f32_32x32x16_bf16 a[192:207], a[36:39], v[96:99], a[192:207]
  v_mov_b32 v34, 0
  v_mov_b32 v35, 0
  v_mfma_f32_32x32x16_bf16 a[208:223], a[32:35], v[100:103], a[208:223]
  buffer_load_dwordx4 v[148:151], v17, s[40:43], s61 offen offset:0 sc1
  v_mov_b32 v36, 0
  v_mov_b32 v37, 0
  v_mfma_f32_32x32x16_bf16 a[224:239], a[36:39], v[100:103], a[224:239]
  v_mov_b32 v38, 0
  v_mov_b32 v39, 0
  s_waitcnt vmcnt(11)
  v_mfma_f32_32x32x16_bf16 a[176:191], a[40:43], v[104:107], a[176:191]
  buffer_load_dwordx4 v[152:155], v17, s[40:43], s60 offen offset:1024 sc1
  s_add_u32 s60, s60, 2048
  v_mov_b32 v40, 0
  v_mov_b32 v41, 0
  v_mfma_f32_32x32x16_bf16 a[192:207], a[44:47], v[104:107], a[192:207]
  v_mov_b32 v42, 0
  v_mov_b32 v43, 0
  v_mfma_f32_32x32x16_bf16 a[208:223], a[40:43], v[108:111], a[208:223]
  buffer_load_dwordx4 v[156:159], v17, s[40:43], s61 offen offset:1024 sc1
  s_add_u32 s61, s61, 2048
  v_mov_b32 v44, 0
  v_mov_b32 v45, 0
  v_mfma_f32_32x32x16_bf16 a[224:239], a[44:47], v[108:111], a[224:239]
  v_mov_b32 v46, 0
  v_mov_b32 v47, 0
  s_waitcnt vmcnt(11)
  v_mfma_f32_32x32x16_bf16 a[176:191], a[48:51], v[112:115], a[176:191]
  buffer_load_dwordx4 v[160:163], v17, s[40:43], s60 offen offset:0 sc1
  v_mfma_f32_32x32x16_bf16 a[192:207], a[52:55], v[112:115], a[192:207]
  v_mfma_f32_32x32x16_bf16 a[208:223], a[48:51], v[116:119], a[208:223]
  buffer_load_dwordx4 v[164:167], v17, s[40:43], s61 offen offset:0 sc1
  v_mfma_f32_32x32x16_bf16 a[224:239], a[52:55], v[116:119], a[224:239]
  s_waitcnt vmcnt(10)
  v_mfma_f32_32x32x16_bf16 a[176:191], a[56:59], v[120:123], a[176:191]
  buffer_load_dwordx4 v[168:171], v17, s[40:43], s60 offen offset:1024 sc1
  s_add_u32 s60, s60, 2048
  v_mfma_f32_32x32x16_bf16 a[192:207], a[60:63], v[120:123], a[192:207]
  v_mfma_f32_32x32x16_bf16 a[208:223], a[56:59], v[124:127], a[208:223]
  buffer_load_dwordx4 v[172:175], v17, s[40:43], s61 offen offset:1024 sc1
  s_add_u32 s61, s61, 2048
  v_mfma_f32_32x32x16_bf16 a[224:239], a[60:63], v[124:127], a[224:239]
  s_waitcnt vmcnt(10)
  v_mfma_f32_32x32x16_bf16 a[176:191], a[64:67], v[128:131], a[176:191]
  buffer_load_dwordx4 v[176:179], v17, s[40:43], s60 offen offset:0 sc1
  v_mfma_f32_32x32x16_bf16 a[192:207], a[68:71], v[128:131], a[192:207]
  v_mfma_f32_32x32x16_bf16 a[208:223], a[64:67], v[132:135], a[208:223]
  buffer_load_dwordx4 v[180:183], v17, s[40:43], s61 offen offset:0 sc1
  v_mfma_f32_32x32x16_bf16 a[224:239], a[68:71], v[132:135], a[224:239]
  s_waitcnt vmcnt(10)
  v_mfma_f32_32x32x16_bf16 a[176:191], a[72:75], v[136:139], a[176:191]
  buffer_load_dwordx4 v[184:187], v17, s[40:43], s60 offen offset:1024 sc1
  s_add_u32 s60, s60, 2048
  v_mfma_f32_32x32x16_bf16 a[192:207], a[76:79], v[136:139], a[192:207]
  v_mfma_f32_32x32x16_bf16 a[208:223], a[72:75], v[140:143], a[208:223]
  buffer_load_dwordx4 v[188:191], v17, s[40:43], s61 offen offset:1024 sc1
  s_add_u32 s61, s61, 2048
  v_mfma_f32_32x32x16_bf16 a[224:239], a[76:79], v[140:143], a[224:239]
  s_waitcnt vmcnt(10)
  v_mfma_f32_32x32x16_bf16 a[176:191], a[80:83], v[144:147], a[176:191]
  buffer_load_dwordx4 v[192:195], v17, s[40:43], s60 offen offset:0 sc1
  v_mfma_f32_32x32x16_bf16 a[192:207], a[84:87], v[144:147], a[192:207]
  v_mfma_f32_32x32x16_bf16 a[208:223], a[80:83], v[148:151], a[208:223]
  buffer_load_dwordx4 v[196:199], v17, s[40:43], s61 offen offset:0 sc1
  v_mfma_f32_32x32x16_bf16 a[224:239], a[84:87], v[148:151], a[224:239]
  s_waitcnt vmcnt(10)
  v_mfma_f32_32x32x16_bf16 a[176:191], a[88:91], v[152:155], a[176:191]
  buffer_load_dwordx4 v[200:203], v17, s[40:43], s60 offen offset:1024 sc1
  s_add_u32 s60, s60, 2048
  v_mfma_f32_32x32x16_bf16 a[192:207], a[92:95], v[152:155], a[192:207]
  v_mfma_f32_32x32x16_bf16 a[208:223], a[88:91], v[156:159], a[208:223]
  buffer_load_dwordx4 v[204:207], v17, s[40:43], s61 offen offset:1024 sc1
  s_add_u32 s61, s61, 2048
  v_mfma_f32_32x32x16_bf16 a[224:239], a[92:95], v[156:159], a[224:239]
  s_waitcnt vmcnt(10)
  v_mfma_f32_32x32x16_bf16 a[176:191], a[96:99], v[160:163], a[176:191]
  buffer_load_dwordx4 v[208:211], v17, s[40:43], s60 offen offset:0 sc1
  v_mfma_f32_32x32x16_bf16 a[192:207], a[100:103], v[160:163], a[192:207]
  buffer_load_dwordx4 v[212:215], v17, s[40:43], s61 offen offset:0 sc1
  v_mfma_f32_32x32x16_bf16 a[208:223], a[96:99], v[164:167], a[208:223]
  buffer_load_dwordx4 v[216:219], v17, s[40:43], s60 offen offset:1024 sc1
  s_add_u32 s60, s60, 2048
  v_mfma_f32_32x32x16_bf16 a[224:239], a[100:103], v[164:167], a[224:239]
  buffer_load_dwordx4 v[220:223], v17, s[40:43], s61 offen offset:1024 sc1
  s_add_u32 s61, s61, 2048
  s_waitcnt vmcnt(12)
  v_mfma_f32_32x32x16_bf16 a[176:191], a[104:107], v[168:171], a[176:191]
  buffer_load_dwordx4 v[20:23], v14, s[8:11], s62 offen
  v_mfma_f32_32x32x16_bf16 a[192:207], a[108:111], v[168:171], a[192:207]
  buffer_load_dwordx4 v[24:27], v15, s[8:11], s62 offen
  v_mfma_f32_32x32x16_bf16 a[208:223], a[104:107], v[172:175], a[208:223]
  buffer_load_dwordx2 v[28:29], v16, s[40:43], s63 offen sc1
  v_mfma_f32_32x32x16_bf16 a[224:239], a[108:111], v[172:175], a[224:239]
  buffer_load_dwordx2 v[30:31], v16, s[40:43], s63 offen offset:256 sc1
  s_waitcnt lgkmcnt(0)
  s_waitcnt vmcnt(14)
  v_mfma_f32_32x32x16_bf16 a[176:191], a[112:115], v[176:179], a[176:191]
  s_sub_u32 s60, s60, s66
  buffer_load_dwordx4 v[224:227], v17, s[40:43], s60 offen offset:0 sc1
  v_mfma_f32_32x32x16_bf16 a[192:207], a[116:119], v[176:179], a[192:207]
  v_mfma_f32_32x32x16_bf16 a[208:223], a[112:115], v[180:183], a[208:223]
  s_sub_u32 s61, s61, s66
  buffer_load_dwordx4 v[228:231], v17, s[40:43], s61 offen offset:0 sc1
  v_mfma_f32_32x32x16_bf16 a[224:239], a[116:119], v[180:183], a[224:239]
  s_waitcnt vmcnt(14)
  v_mfma_f32_32x32x16_bf16 a[176:191], a[120:123], v[184:187], a[176:191]
  buffer_load_dwordx4 v[232:235], v17, s[40:43], s60 offen offset:1024 sc1
  s_add_u32 s60, s60, 2048
  v_mfma_f32_32x32x16_bf16 a[192:207], a[124:127], v[184:187], a[192:207]
  v_mfma_f32_32x32x16_bf16 a[208:223], a[120:123], v[188:191], a[208:223]
  buffer_load_dwordx4 v[236:239], v17, s[40:43], s61 offen offset:1024 sc1
  s_add_u32 s61, s61, 2048
  v_mfma_f32_32x32x16_bf16 a[224:239], a[124:127], v[188:191], a[224:239]
  s_waitcnt vmcnt(14)
  v_mfma_f32_32x32x16_bf16 a[176:191], a[128:131], v[192:195], a[176:191]
  s_mov_b64 exec, s[48:49]
  buffer_load_dword v10, v8, s[40:43], 0 offen sc1
  s_mov_b64 exec, -1
  s_waitcnt vmcnt(5)
  s_mov_b32 s4, 0xffff0000
  v_lshlrev_b32 v64, 16, v20
  v_and_b32 v65, s4, v20
  v_mfma_f32_32x32x16_bf16 a[192:207], a[132:135], v[192:195], a[192:207]
  v_lshlrev_b32 v66, 16, v21
  v_and_b32 v67, s4, v21
  v_lshlrev_b32 v68, 16, v22
  v_mfma_f32_32x32x16_bf16 a[208:223], a[128:131], v[196:199], a[208:223]
  v_and_b32 v69, s4, v22
  v_lshlrev_b32 v70, 16, v23
  v_and_b32 v71, s4, v23
  v_mfma_f32_32x32x16_bf16 a[224:239], a[132:135], v[196:199], a[224:239]
  v_lshlrev_b32 v72, 16, v24
  v_and_b32 v73, s4, v24
  v_lshlrev_b32 v74, 16, v25
  v_mfma_f32_32x32x16_bf16 a[176:191], a[136:139], v[200:203], a[176:191]
  v_and_b32 v75, s4, v25
  v_lshlrev_b32 v76, 16, v26
  v_and_b32 v77, s4, v26
  v_lshlrev_b32 v78, 16, v27
  v_mfma_f32_32x32x16_bf16 a[192:207], a[140:143], v[200:203], a[192:207]
  v_and_b32 v79, s4, v27
  v_sub_f32 v80, v64, v28
  v_sub_f32 v81, v65, v28
  v_mfma_f32_32x32x16_bf16 a[208:223], a[136:139], v[204:207], a[208:223]
  v_sub_f32 v82, v66, v28
  v_sub_f32 v83, v67, v28
  v_sub_f32 v84, v68, v28
  v_mfma_f32_32x32x16_bf16 a[224:239], a[140:143], v[204:207], a[224:239]
  v_sub_f32 v85, v69, v28
  v_sub_f32 v86, v70, v28
  v_sub_f32 v87, v71, v28
  v_mfma_f32_32x32x16_bf16 a[176:191], a[144:147], v[208:211], a[176:191]
  v_sub_f32 v88, v72, v30
  v_sub_f32 v89, v73, v30
  v_sub_f32 v90, v74, v30
  v_mfma_f32_32x32x16_bf16 a[192:207], a[148:151], v[208:211], a[192:207]
  v_sub_f32 v91, v75, v30
  v_sub_f32 v92, v76, v30
  v_sub_f32 v93, v77, v30
  v_mfma_f32_32x32x16_bf16 a[208:223], a[144:147], v[212:215], a[208:223]
  v_sub_f32 v94, v78, v30
  v_sub_f32 v95, v79, v30
  v_mul_f32 v80, v80, v29
  v_mfma_f32_32x32x16_bf16 a[224:239], a[148:151], v[212:215], a[224:239]
  v_mul_f32 v81, v81, v29
  v_mul_f32 v82, v82, v29
  v_mul_f32 v83, v83, v29
  v_mfma_f32_32x32x16_bf16 a[176:191], a[152:155], v[216:219], a[176:191]
  v_mul_f32 v84, v84, v29
  v_mul_f32 v85, v85, v29
  v_mul_f32 v86, v86, v29
  v_mfma_f32_32x32x16_bf16 a[192:207], a[156:159], v[216:219], a[192:207]
  v_mul_f32 v87, v87, v29
  v_mul_f32 v88, v88, v31
  v_mul_f32 v89, v89, v31
  v_mfma_f32_32x32x16_bf16 a[208:223], a[152:155], v[220:223], a[208:223]
  v_mul_f32 v90, v90, v31
  v_mul_f32 v91, v91, v31
  v_mul_f32 v92, v92, v31
  v_mfma_f32_32x32x16_bf16 a[224:239], a[156:159], v[220:223], a[224:239]
  v_mul_f32 v93, v93, v31
  v_mul_f32 v94, v94, v31
  v_mul_f32 v95, v95, v31
  s_waitcnt vmcnt(0)
  s_mov_b64 exec, s[48:49]
  s_mov_b32 s3, 0x8000
LB10:
  v_cmp_ne_u32 vcc, s47, v10
  s_nop 0
  s_cbranch_vccz LB11
  s_sub_u32 s3, s3, 1
  s_cbranch_scc1 LB11
  buffer_load_dword v10, v8, s[40:43], 0 offen sc1
  s_waitcnt vmcnt(0)
  s_branch LB10
LB11:
  s_mov_b64 exec, -1
  s_barrier
  s_add_u32 m0, s70, 155648
  s_nop 0
  buffer_load_dwordx4 v2, s[40:43], s67 offen sc1 lds
  s_add_u32 m0, s70, 156672
  s_nop 0
  buffer_load_dwordx4 v3, s[40:43], s67 offen sc1 lds
  s_cmp_eq_u32 s46, 3
  s_cbranch_scc1 LB12
  v_mfma_f32_32x32x16_bf16 a[176:191], a[160:163], v[224:227], a[176:191]
  v_mfma_f32_32x32x16_bf16 a[176:191], a[168:171], v[232:235], a[176:191]
  v_mfma_f32_32x32x16_bf16 a[192:207], a[164:167], v[224:227], a[192:207]
  v_mfma_f32_32x32x16_bf16 a[192:207], a[172:175], v[232:235], a[192:207]
  v_mfma_f32_32x32x16_bf16 a[208:223], a[160:163], v[228:231], a[208:223]
  s_nop 7
  ds_write_b128 v12, a[176:179] offset:0
  ds_write_b128 v12, a[180:183] offset:32
  v_mfma_f32_32x32x16_bf16 a[208:223], a[168:171], v[236:239], a[208:223]
  ds_write_b128 v12, a[184:187] offset:64
  ds_write_b128 v12, a[188:191] offset:96
  v_mfma_f32_32x32x16_bf16 a[224:239], a[164:167], v[228:231], a[224:239]
  ds_write_b128 v12, a[192:195] offset:128
  ds_write_b128 v12, a[196:199] offset:160
  v_mfma_f32_32x32x16_bf16 a[224:239], a[172:175], v[236:239], a[224:239]
  ds_write_b128 v12, a[200:203] offset:192
  ds_write_b128 v12, a[204:207] offset:224
  s_nop 3
  ds_write_b128 v12, a[208:211] offset:8704
  ds_write_b128 v12, a[212:215] offset:8736
  ds_write_b128 v12, a[216:219] offset:8768
  ds_write_b128 v12, a[220:223] offset:8800
  s_nop 7
  ds_write_b128 v12, a[224:227] offset:8832
  ds_write_b128 v12, a[228:231] offset:8864
  ds_write_b128 v12, a[232:235] offset:8896
  ds_write_b128 v12, a[236:239] offset:8928
  s_branch LB13
LB12:
  s_nop 15
  ds_write_b128 v12, a[176:179] offset:0
  ds_write_b128 v12, a[180:183] offset:32
  ds_write_b128 v12, a[184:187] offset:64
  ds_write_b128 v12, a[188:191] offset:96
  ds_write_b128 v12, a[192:195] offset:128
  ds_write_b128 v12, a[196:199] offset:160
  ds_write_b128 v12, a[200:203] offset:192
  ds_write_b128 v12, a[204:207] offset:224
  ds_write_b128 v12, a[208:211] offset:8704
  ds_write_b128 v12, a[212:215] offset:8736
  ds_write_b128 v12, a[216:219] offset:8768
  ds_write_b128 v12, a[220:223] offset:8800
  ds_write_b128 v12, a[224:227] offset:8832
  ds_write_b128 v12, a[228:231] offset:8864
  ds_write_b128 v12, a[232:235] offset:8896
  ds_write_b128 v12, a[236:239] offset:8928
LB13:
  s_waitcnt vmcnt(0)
  s_waitcnt lgkmcnt(0)
  s_barrier
  ds_read_u16_d16_hi v32, v13 offset:0
  ds_read_u16_d16_hi v33, v13 offset:128
  ds_read_u16_d16_hi v34, v13 offset:256
  ds_read_u16_d16_hi v35, v13 offset:384
  ds_read_u16_d16_hi v36, v13 offset:512
  ds_read_u16_d16_hi v37, v13 offset:640
  ds_read_u16_d16_hi v38, v13 offset:768
  ds_read_u16_d16_hi v39, v13 offset:896
  ds_read_b128 v[96:99], v6 offset:0
  ds_read_b128 v[100:103], v6 offset:16
  ds_read_b128 v[104:107], v6 offset:17408
  ds_read_b128 v[108:111], v6 offset:17424
  ds_read_b128 v[112:115], v6 offset:34816
  ds_read_b128 v[116:119], v6 offset:34832
  ds_read_b128 v[120:123], v6 offset:52224
  ds_read_b128 v[124:127], v6 offset:52240
  ds_read_u16_d16_hi v40, v7 offset:0
  ds_read_u16_d16_hi v41, v7 offset:128
  ds_read_u16_d16_hi v42, v7 offset:256
  ds_read_u16_d16_hi v43, v7 offset:384
  ds_read_u16_d16_hi v44, v7 offset:512
  ds_read_u16_d16_hi v45, v7 offset:640
  ds_read_u16_d16_hi v46, v7 offset:768
  ds_read_u16_d16_hi v47, v7 offset:896
  ds_read_b128 v[128:131], v6 offset:8704
  ds_read_b128 v[132:135], v6 offset:8720
  ds_read_b128 v[136:139], v6 offset:26112
  ds_read_b128 v[140:143], v6 offset:26128
  ds_read_b128 v[144:147], v6 offset:43520
  ds_read_b128 v[148:151], v6 offset:43536
  ds_read_b128 v[152:155], v6 offset:60928
  ds_read_b128 v[156:159], v6 offset:60944
  s_waitcnt lgkmcnt(15)
  v_fmac_f32 v64, v80, v32
  v_fmac_f32 v65, v81, v33
  v_fmac_f32 v66, v82, v34
  v_fmac_f32 v67, v83, v35
  v_fmac_f32 v68, v84, v36
  v_fmac_f32 v69, v85, v37
  v_fmac_f32 v70, v86, v38
  v_fmac_f32 v71, v87, v39
  s_waitcnt lgkmcnt(15)
  v_add_f32 v96, v96, v104
  v_add_f32 v112, v112, v120
  v_add_f32 v97, v97, v105
  v_add_f32 v113, v113, v121
  v_add_f32 v98, v98, v106
  v_add_f32 v114, v114, v122
  v_add_f32 v99, v99, v107
  v_add_f32 v115, v115, v123
  v_add_f32 v100, v100, v108
  v_add_f32 v116, v116, v124
  v_add_f32 v101, v101, v109
  v_add_f32 v117, v117, v125
  v_add_f32 v102, v102, v110
  v_add_f32 v118, v118, v126
  v_add_f32 v103, v103, v111
  v_add_f32 v119, v119, v127
  v_add_f32 v96, v96, v112
  v_add_f32 v97, v97, v113
  v_add_f32 v98, v98, v114
  v_add_f32 v99, v99, v115
  v_add_f32 v100, v100, v116
  v_add_f32 v101, v101, v117
  v_add_f32 v102, v102, v118
  v_add_f32 v103, v103, v119
  v_fmac_f32 v64, v96, v29
  v_fmac_f32 v65, v97, v29
  v_fmac_f32 v66, v98, v29
  v_fmac_f32 v67, v99, v29
  v_fmac_f32 v68, v100, v29
  v_fmac_f32 v69, v101, v29
  v_fmac_f32 v70, v102, v29
  v_fmac_f32 v71, v103, v29
  v_cvt_pk_bf16_f32 v48, v64, v65
  v_cvt_pk_bf16_f32 v49, v66, v67
  v_cvt_pk_bf16_f32 v50, v68, v69
  v_cvt_pk_bf16_f32 v51, v70, v71
  buffer_store_dwordx4 v[48:51], v14, s[36:39], s62 offen sc0 sc1
  s_waitcnt lgkmcnt(8)
  v_fmac_f32 v72, v88, v40
  v_fmac_f32 v73, v89, v41
  v_fmac_f32 v74, v90, v42
  v_fmac_f32 v75, v91, v43
  v_fmac_f32 v76, v92, v44
  v_fmac_f32 v77, v93, v45
  v_fmac_f32 v78, v94, v46
  v_fmac_f32 v79, v95, v47
  s_waitcnt lgkmcnt(0)
  v_add_f32 v128, v128, v136
  v_add_f32 v144, v144, v152
  v_add_f32 v129, v129, v137
  v_add_f32 v145, v145, v153
  v_add_f32 v130, v130, v138
  v_add_f32 v146, v146, v154
  v_add_f32 v131, v131, v139
  v_add_f32 v147, v147, v155
  v_add_f32 v132, v132, v140
  v_add_f32 v148, v148, v156
  v_add_f32 v133, v133, v141
  v_add_f32 v149, v149, v157
  v_add_f32 v134, v134, v142
  v_add_f32 v150, v150, v158
  v_add_f32 v135, v135, v143
  v_add_f32 v151, v151, v159
  v_add_f32 v128, v128, v144
  v_add_f32 v129, v129, v145
  v_add_f32 v130, v130, v146
  v_add_f32 v131, v131, v147
  v_add_f32 v132, v132, v148
  v_add_f32 v133, v133, v149
  v_add_f32 v134, v134, v150
  v_add_f32 v135, v135, v151
  v_fmac_f32 v72, v128, v31
  v_fmac_f32 v73, v129, v31
  v_fmac_f32 v74, v130, v31
  v_fmac_f32 v75, v131, v31
  v_fmac_f32 v76, v132, v31
  v_fmac_f32 v77, v133, v31
  v_fmac_f32 v78, v134, v31
  v_fmac_f32 v79, v135, v31
  v_cvt_pk_bf16_f32 v52, v72, v73
  v_cvt_pk_bf16_f32 v53, v74, v75
  v_cvt_pk_bf16_f32 v54, v76, v77
  v_cvt_pk_bf16_f32 v55, v78, v79
  buffer_store_dwordx4 v[52:55], v15, s[36:39], s62 offen sc0 sc1
LEND:
s_endpgm
.section .rodata,"a"
.p2align 6
.amdhsa_kernel parallel_sum__ssm_conv_h3__dense_activation_relu__prompt_kernel
  .amdhsa_next_free_vgpr 512
  .amdhsa_next_free_sgpr 102
  .amdhsa_accum_offset 256
  .amdhsa_group_segment_fixed_size 0
  .amdhsa_kernarg_size 96
  .amdhsa_user_sgpr_count 2
  .amdhsa_user_sgpr_kernarg_segment_ptr 1
  .amdhsa_system_sgpr_workgroup_id_x 1
.end_amdhsa_kernel
```
